```python
import torch

def _softmax(x, axis=-1):
    return torch.softmax(x, dim=axis)
def _gelu(x):
    return torch.nn.functional.gelu(x, approximate="tanh")
def _silu(x):
    return torch.nn.functional.silu(x)
def _sigmoid(x):
    return torch.sigmoid(x)
def _layernorm(x, axis=-1, eps=1e-5):
    m = x.mean(dim=axis, keepdim=True)
    v = x.var(dim=axis, keepdim=True, unbiased=False)
    return (x - m) / torch.sqrt(v + eps)
def _scatter_add(tgt, idx, src, axis=0):
    return tgt.clone().index_add_(axis, idx, src)
def _segment_sum(src, seg, n):
    out = torch.zeros((n,) + src.shape[1:], dtype=src.dtype)
    return out.index_add_(0, seg, src)
def _pad(x, pw):
    flat = tuple(v for pair in reversed(pw) for v in pair)
    return torch.nn.functional.pad(x, flat)

kernel_name = 'standalone__cross_network_dcn_v2__recsys'

def setup_inputs():

    _w = (lambda a: (lambda t: t.to(torch.bfloat16) if t.is_floating_point() else t)(torch.as_tensor(a)))
    B, F, D, L = 16384, 26, 16, 3
    Din = min(F * D, 512)
    R = max(Din // 4, 2)
    sc = Din ** -0.5
    return {
        "x0": _w((lambda *s: torch.randn(*s, dtype=torch.bfloat16) * 0.05)(B, Din)),
        "U":  _w((lambda *s: torch.randn(*s, dtype=torch.bfloat16) * 1.6)(L, Din, R) * sc),
        "V":  _w((lambda *s: torch.randn(*s, dtype=torch.bfloat16) * 1.6)(L, R, Din) * sc),
        "bs": _w((lambda *s: torch.randn(*s, dtype=torch.bfloat16) * 0.05)(L, Din)),
    }

def reference(x0, U, V, bs):
    x = x0
    for l in range(U.shape[0]):
        h = torch.einsum('rd,bd->br', V[l], x)
        h = torch.einsum('dr,br->bd', U[l], h)
        x = x0 * (h + bs[l]) + x
    return x
```

```asm
; @launch grid=(256,1,1) block=(256,1,1) lds=163840
.amdgcn_target "amdgcn-amd-amdhsa--gfx950"
.text
.globl standalone__cross_network_dcn_v2__recsys_kernel
.p2align 8
.type standalone__cross_network_dcn_v2__recsys_kernel,@function
standalone__cross_network_dcn_v2__recsys_kernel:
    s_cmp_ge_u32 s2, 256
    s_cbranch_scc1 L_end
    s_load_dwordx2 s[16:17], s[0:1], 0
    s_load_dwordx2 s[24:25], s[0:1], 16
    s_load_dwordx2 s[28:29], s[0:1], 24
    s_load_dwordx2 s[20:21], s[0:1], 8
    s_load_dwordx2 s[32:33], s[0:1], 32
    s_getpc_b64 s[80:81]
    v_lshrrev_b32 v6, 6, v0
    v_and_b32 v1, 63, v0
    v_readfirstlane_b32 s36, v6
    v_and_b32 v2, 15, v0
    v_bfe_u32 v3, v0, 4, 2
    v_lshlrev_b32 v252, 4, v1
    s_lshl_b32 s3, s2, 2
    s_add_u32 s3, s3, s36
    v_lshl_add_u32 v8, s3, 4, v2
    v_mul_u32_u24 v253, 832, v8
    v_lshl_add_u32 v253, v3, 4, v253
    s_mul_i32 s3, s3, 13312
    v_lshrrev_b32 v8, 3, v1
    v_mul_u32_u24 v98, 1664, v8
    v_and_b32 v8, 7, v0
    v_xor_b32 v8, v8, v3
    v_lshl_add_u32 v98, v8, 4, v98
    v_add_u32 v98, s3, v98
    s_mov_b32 s18, 13631488
    s_mov_b32 s19, 0x00020000
    s_mov_b32 s26, 259584
    s_mov_b32 s27, 0x00020000
    s_mov_b32 s30, 2496
    s_mov_b32 s31, 0x00020000
    s_lshl_b32 s38, s36, 10
    s_bfe_u32 s4, s2, 0x50003
    s_mul_i32 s5, s4, 3072
    s_add_u32 s5, s5, s38
    s_mul_i32 s6, s4, 640
    s_and_b32 s80, s80, 0xffffff00
    s_and_b32 s81, s81, 0xffff
    s_mov_b32 s83, 0x00020000
    s_add_u32 m0, s38, 157696
    s_cmp_lt_u32 s36, 3
    s_cselect_b32 s5, s5, s6
    s_cselect_b32 s6, 16, 12
    s_cselect_b32 s82, s26, L_end-standalone__cross_network_dcn_v2__recsys_kernel
    v_mul_u32_u24 v9, s6, v1
    s_waitcnt lgkmcnt(0)
    s_cselect_b32 s80, s24, s80
    s_cselect_b32 s81, s25, s81
    buffer_load_dword a136, v9, s[80:83], s5 offen
    buffer_load_dwordx4 v252, s[28:31], s38 offen lds
    s_add_u32 m0, s38, 127232
    s_nop 0
    buffer_load_dwordx4 v98, s[16:19], 0 offen offset:768 lds
    s_add_u32 m0, s38, 78848
    s_nop 0
    buffer_load_dwordx4 v98, s[16:19], 0 offen lds
    s_add_u32 m0, s38, 82048
    s_nop 0
    buffer_load_dwordx4 v98, s[16:19], 0 offen offset:896 lds
    s_add_u32 m0, s38, 86912
    s_nop 0
    buffer_load_dwordx4 v98, s[16:19], 0 offen offset:128 lds
    s_add_u32 m0, s38, 90112
    s_nop 0
    buffer_load_dwordx4 v98, s[16:19], 0 offen offset:1024 lds
    s_add_u32 m0, s38, 94976
    s_nop 0
    buffer_load_dwordx4 v98, s[16:19], 0 offen offset:256 lds
    s_add_u32 m0, s38, 98176
    s_nop 0
    buffer_load_dwordx4 v98, s[16:19], 0 offen offset:1152 lds
    s_add_u32 m0, s38, 103040
    s_nop 0
    buffer_load_dwordx4 v98, s[16:19], 0 offen offset:384 lds
    s_add_u32 m0, s38, 106240
    s_nop 0
    buffer_load_dwordx4 v98, s[16:19], 0 offen offset:1280 lds
    s_mov_b32 s34, 13631488
    s_mov_b32 s35, 0x00020000
    s_mov_b32 s54, 259584
    s_mov_b32 s55, 0x00020000
    s_mov_b32 s7, 0
    s_mov_b32 s78, 26624
    s_mov_b32 s79, 53248
    v_bfe_u32 v4, v0, 2, 2
    v_and_b32 v5, 3, v0
    s_mul_i32 s37, s36, 1056
    s_mul_i32 s3, s36, 6656
    v_mul_u32_u24 v6, 1664, v4
    v_lshl_add_u32 v6, v5, 4, v6
    v_add_u32 v6, s3, v6
    v_bfe_u32 v7, v0, 5, 1
    v_bfe_u32 v8, v0, 4, 1
    v_mul_u32_u24 v251, 896, v8
    v_lshl_add_u32 v251, v7, 6, v251
    v_add_u32 v251, v6, v251
    v_mul_u32_u24 v255, 86592, v8
    v_mul_u32_u24 v7, 26624, v7
    v_add3_u32 v255, v255, v7, v6
    v_add_u32 v255, 768, v255
    v_mul_u32_u24 v99, 26624, v3
    v_add_u32 v99, v99, v6
    v_add_u32 v99, 832, v99
    s_lshl_b32 s3, s4, 1
    s_and_b32 s5, s36, 1
    s_add_u32 s3, s3, s5
    v_lshl_add_u32 v9, s3, 6, v1
    s_cmp_lt_u32 s36, 2
    s_cselect_b32 s52, s20, s24
    s_cselect_b32 s53, s21, s25
    s_cselect_b32 s85, 0, 86528
    v_mul_u32_u24 v100, 24, v9
    s_cselect_b32 s3, 44, 24
    v_mul_u32_u24 v101, s3, v9
    s_add_u32 s86, s85, 86528
    s_sub_u32 s8, s20, 66560
    s_subb_u32 s9, s21, 0
    s_mov_b32 s10, 326144
    s_mov_b32 s11, 0x00020000
    s_add_u32 s12, s20, 0
    s_addc_u32 s13, s21, 0
    s_mov_b32 s14, 259584
    s_mov_b32 s15, 0x00020000
    s_add_u32 s28, s20, 66560
    s_addc_u32 s29, s21, 0
    s_mov_b32 s30, 193024
    s_mov_b32 s31, 0x00020000
    s_add_u32 s80, s20, 133120
    s_addc_u32 s81, s21, 0
    s_mov_b32 s82, 126464
    s_mov_b32 s83, 0x00020000
    s_add_u32 s20, s20, 98304
    s_addc_u32 s21, s21, 0
    s_mov_b32 s22, 161280
    s_mov_b32 s23, 0x00020000
    v_min_u32 v10, 2, v3
    v_mul_u32_u24 v102, 832, v10
    v_lshl_add_u32 v102, v2, 2, v102
    v_add_u32 v102, 157696, v102
    v_mul_u32_u24 v248, 1056, v4
    v_lshl_add_u32 v248, v5, 6, v248
    v_lshl_add_u32 v248, v3, 4, v248
    v_mul_u32_u24 v6, 416, v2
    v_add_u32 v6, 66560, v6
    v_lshl_add_u32 v249, v3, 4, v6
    v_lshrrev_b32 v7, 1, v3
    v_xor_b32 v8, v7, v3
    v_and_b32 v8, 1, v8
    v_mul_u32_u24 v7, 208, v7
    v_lshl_add_u32 v250, v8, 3, v6
    v_add_u32 v250, v7, v250
    v_add_u32 v250, 192, v250
    v_lshrrev_b32 v6, 1, v4
    v_xor_b32 v6, v6, v4
    v_and_b32 v6, 1, v6
    v_lshl_add_u32 v6, v6, 2, v5
    v_mul_u32_u24 v254, 832, v6
    v_lshl_add_u32 v254, v3, 4, v254
    v_add_u32 v254, 133120, v254
    v_xor_b32 v6, v3, v4
    v_lshlrev_b32 v6, 4, v6
    v_lshrrev_b32 v7, 1, v2
    v_lshl_add_u32 v6, v7, 7, v6
    s_add_u32 s3, s38, 78848
    v_add_u32 v6, s3, v6
    v_and_b32 v7, 1, v2
    v_mul_u32_u24 v8, 4032, v7
    v_sub_u32 v97, v6, v8
    v_add3_u32 v96, v6, v8, 64
    v_mul_u32_u24 v8, 49216, v7
    v_add_u32 v95, v6, v8
    s_mov_b32 s40, -1
    s_mov_b32 s41, 0
    s_mov_b32 s51, 0xffff0000
    s_cmp_lt_u32 s36, 1
    s_mov_b32 s3, 132096
    s_cselect_b32 s48, s3, 65536
    s_add_u32 s48, s48, s38
    s_cmp_lt_u32 s36, 2
    s_mov_b32 s3, 131072
    s_cselect_b32 s49, s3, 64512
    s_add_u32 s49, s49, s38
    s_cmp_lt_u32 s36, 3
    s_mov_b32 s3, 130048
    s_cselect_b32 s50, s3, 63488
    s_add_u32 s50, s50, s38
    s_cmp_lt_u32 s36, 2
    s_mov_b32 s3, 104448
    s_cselect_b32 s84, s3, 139264
    s_add_u32 s84, s84, s38
    v_accvgpr_write_b32 a51, 0
    v_accvgpr_write_b32 a55, 0
    v_accvgpr_write_b32 a59, 0
    v_accvgpr_write_b32 a63, 0
    v_accvgpr_write_b32 a67, 0
    v_accvgpr_write_b32 a71, 0
    v_accvgpr_write_b32 a75, 0
    v_accvgpr_write_b32 a79, 0
    v_accvgpr_write_b32 a83, 0
    v_accvgpr_write_b32 a87, 0
    v_accvgpr_write_b32 a91, 0
    v_accvgpr_write_b32 a95, 0
    v_accvgpr_write_b32 a99, 0
    v_cmp_eq_u32 vcc, 0, v3
    v_accvgpr_write_b32 a115, 0
    v_accvgpr_write_b32 a119, 0
    v_cndmask_b32 v6, 0, 1.0, vcc
    v_lshrrev_b32 v7, 16, v6
    v_accvgpr_write_b32 a118, v6
    v_accvgpr_write_b32 a114, v7
    v_cmp_eq_u32 vcc, 1, v3
    v_accvgpr_write_b32 a123, 0
    v_accvgpr_write_b32 a127, 0
    v_cndmask_b32 v6, 0, 1.0, vcc
    v_lshrrev_b32 v7, 16, v6
    v_accvgpr_write_b32 a126, v6
    v_accvgpr_write_b32 a122, v7
    v_cmp_eq_u32 vcc, 2, v3
    v_accvgpr_write_b32 a131, 0
    v_accvgpr_write_b32 a135, 0
    v_cndmask_b32 v6, 0, 1.0, vcc
    v_lshrrev_b32 v7, 16, v6
    v_accvgpr_write_b32 a134, v6
    v_accvgpr_write_b32 a130, v7
    s_add_u32 m0, s38, 111104
    s_nop 0
    buffer_load_dwordx4 v98, s[16:19], 0 offen offset:512 lds
    s_add_u32 m0, s38, 114304
    s_nop 0
    buffer_load_dwordx4 v98, s[16:19], 0 offen offset:1408 lds
    s_add_u32 m0, s38, 119168
    s_nop 0
    buffer_load_dwordx4 v98, s[16:19], 0 offen offset:640 lds
    s_add_u32 m0, s38, 122368
    s_nop 0
    buffer_load_dwordx4 v98, s[16:19], 0 offen offset:1536 lds
    s_waitcnt vmcnt(13)
    s_barrier
    ds_read_b32 a50, v102 offset:0
    ds_read_b32 a54, v102 offset:64
    ds_read_b32 a58, v102 offset:128
    ds_read_b32 a62, v102 offset:192
    ds_read_b32 a66, v102 offset:256
    ds_read_b32 a70, v102 offset:320
    ds_read_b32 a74, v102 offset:384
    ds_read_b32 a78, v102 offset:448
    ds_read_b32 a82, v102 offset:512
    ds_read_b32 a86, v102 offset:576
    ds_read_b32 a90, v102 offset:640
    ds_read_b32 a94, v102 offset:704
    ds_read_b32 a98, v102 offset:768
    buffer_load_dword a137, v100, s[52:55], s85 offen
    s_add_u32 m0, s37, 1024
    s_nop 0
    buffer_load_dwordx4 v251, s[24:27], s7 offen lds
    s_waitcnt vmcnt(13)
    ds_read_b128 v[12:15], v95 offset:0
    s_waitcnt vmcnt(12)
    ds_read_b128 v[16:19], v96 offset:0
    s_waitcnt lgkmcnt(1)
    v_lshlrev_b32 v104, 16, v12
    v_and_b32 v108, s51, v12
    v_lshlrev_b32 v105, 16, v13
    v_and_b32 v109, s51, v13
    v_lshlrev_b32 v106, 16, v14
    v_and_b32 v110, s51, v14
    v_lshlrev_b32 v107, 16, v15
    v_and_b32 v111, s51, v15
    s_waitcnt vmcnt(11)
    ds_read_b128 v[20:23], v97 offset:8192
    s_waitcnt lgkmcnt(1)
    v_lshlrev_b32 v112, 16, v16
    v_and_b32 v116, s51, v16
    v_lshlrev_b32 v113, 16, v17
    v_and_b32 v117, s51, v17
    v_lshlrev_b32 v114, 16, v18
    v_and_b32 v118, s51, v18
    v_lshlrev_b32 v115, 16, v19
    v_and_b32 v119, s51, v19
    s_add_u32 m0, s37, 5248
    s_nop 0
    buffer_load_dwordx4 v251, s[24:27], s78 offen lds
    s_waitcnt vmcnt(11)
    ds_read_b128 v[24:27], v96 offset:8192
    s_waitcnt lgkmcnt(1)
    v_lshlrev_b32 v120, 16, v20
    v_and_b32 v124, s51, v20
    v_lshlrev_b32 v121, 16, v21
    v_and_b32 v125, s51, v21
    v_lshlrev_b32 v122, 16, v22
    v_and_b32 v126, s51, v22
    v_lshlrev_b32 v123, 16, v23
    v_and_b32 v127, s51, v23
    s_add_u32 m0, s37, 9472
    s_nop 0
    buffer_load_dwordx4 v251, s[24:27], s79 offen lds
    s_waitcnt vmcnt(11)
    ds_read_b128 v[28:31], v97 offset:16384
    s_waitcnt lgkmcnt(1)
    v_lshlrev_b32 v128, 16, v24
    v_and_b32 v132, s51, v24
    v_lshlrev_b32 v129, 16, v25
    v_and_b32 v133, s51, v25
    v_lshlrev_b32 v130, 16, v26
    v_and_b32 v134, s51, v26
    v_lshlrev_b32 v131, 16, v27
    v_and_b32 v135, s51, v27
    s_add_u32 m0, s37, 13568
    s_nop 0
    buffer_load_dwordx4 v251, s[24:27], s7 offen offset:128 lds
    s_waitcnt vmcnt(11)
    ds_read_b128 v[32:35], v96 offset:16384
    s_waitcnt lgkmcnt(1)
    v_lshlrev_b32 v136, 16, v28
    v_and_b32 v140, s51, v28
    v_lshlrev_b32 v137, 16, v29
    v_and_b32 v141, s51, v29
    v_lshlrev_b32 v138, 16, v30
    v_and_b32 v142, s51, v30
    v_lshlrev_b32 v139, 16, v31
    v_and_b32 v143, s51, v31
    s_add_u32 m0, s37, 17792
    s_nop 0
    buffer_load_dwordx4 v251, s[24:27], s78 offen offset:128 lds
    s_waitcnt vmcnt(11)
    ds_read_b128 v[36:39], v97 offset:24576
    s_waitcnt lgkmcnt(1)
    v_lshlrev_b32 v144, 16, v32
    v_and_b32 v148, s51, v32
    v_lshlrev_b32 v145, 16, v33
    v_and_b32 v149, s51, v33
    v_lshlrev_b32 v146, 16, v34
    v_and_b32 v150, s51, v34
    v_lshlrev_b32 v147, 16, v35
    v_and_b32 v151, s51, v35
    s_add_u32 m0, s37, 22016
    s_nop 0
    buffer_load_dwordx4 v251, s[24:27], s79 offen offset:128 lds
    s_waitcnt vmcnt(11)
    ds_read_b128 v[40:43], v96 offset:24576
    s_waitcnt lgkmcnt(1)
    v_lshlrev_b32 v152, 16, v36
    v_and_b32 v156, s51, v36
    v_lshlrev_b32 v153, 16, v37
    v_and_b32 v157, s51, v37
    v_lshlrev_b32 v154, 16, v38
    v_and_b32 v158, s51, v38
    v_lshlrev_b32 v155, 16, v39
    v_and_b32 v159, s51, v39
    s_add_u32 m0, s37, 26112
    s_nop 0
    buffer_load_dwordx4 v251, s[24:27], s7 offen offset:256 lds
    s_waitcnt vmcnt(11)
    ds_read_b128 v[44:47], v97 offset:32768
    s_waitcnt lgkmcnt(1)
    v_lshlrev_b32 v160, 16, v40
    v_and_b32 v164, s51, v40
    v_lshlrev_b32 v161, 16, v41
    v_and_b32 v165, s51, v41
    v_lshlrev_b32 v162, 16, v42
    v_and_b32 v166, s51, v42
    v_lshlrev_b32 v163, 16, v43
    v_and_b32 v167, s51, v43
    s_add_u32 m0, s37, 30336
    s_nop 0
    buffer_load_dwordx4 v251, s[24:27], s78 offen offset:256 lds
    s_waitcnt vmcnt(11)
    ds_read_b128 v[48:51], v96 offset:32768
    s_waitcnt lgkmcnt(1)
    v_lshlrev_b32 v168, 16, v44
    v_and_b32 v172, s51, v44
    v_lshlrev_b32 v169, 16, v45
    v_and_b32 v173, s51, v45
    v_lshlrev_b32 v170, 16, v46
    v_and_b32 v174, s51, v46
    v_lshlrev_b32 v171, 16, v47
    v_and_b32 v175, s51, v47
    s_add_u32 m0, s37, 34560
    s_nop 0
    buffer_load_dwordx4 v251, s[24:27], s79 offen offset:256 lds
    s_waitcnt vmcnt(11)
    ds_read_b128 v[52:55], v97 offset:40960
    s_waitcnt lgkmcnt(1)
    v_lshlrev_b32 v176, 16, v48
    v_and_b32 v180, s51, v48
    v_lshlrev_b32 v177, 16, v49
    v_and_b32 v181, s51, v49
    v_lshlrev_b32 v178, 16, v50
    v_and_b32 v182, s51, v50
    v_lshlrev_b32 v179, 16, v51
    v_and_b32 v183, s51, v51
    s_add_u32 m0, s38, 141312
    s_add_u32 s39, s38, 79872
    buffer_load_dwordx4 v252, s[24:27], s39 offen lds
    s_waitcnt vmcnt(11)
    ds_read_b128 v[56:59], v96 offset:40960
    s_waitcnt lgkmcnt(1)
    v_lshlrev_b32 v184, 16, v52
    v_and_b32 v188, s51, v52
    v_lshlrev_b32 v185, 16, v53
    v_and_b32 v189, s51, v53
    v_lshlrev_b32 v186, 16, v54
    v_and_b32 v190, s51, v54
    v_lshlrev_b32 v187, 16, v55
    v_and_b32 v191, s51, v55
    ds_read_b128 v[60:63], v97 offset:49152
    s_waitcnt lgkmcnt(1)
    v_lshlrev_b32 v192, 16, v56
    v_and_b32 v196, s51, v56
    v_lshlrev_b32 v193, 16, v57
    v_and_b32 v197, s51, v57
    v_lshlrev_b32 v194, 16, v58
    v_and_b32 v198, s51, v58
    v_lshlrev_b32 v195, 16, v59
    v_and_b32 v199, s51, v59
    s_add_u32 m0, s38, 145408
    s_add_u32 s39, s38, 83968
    buffer_load_dwordx4 v252, s[24:27], s39 offen lds
    s_add_u32 m0, s37, 38656
    s_nop 0
    buffer_load_dwordx4 v251, s[24:27], s7 offen offset:384 lds
    s_add_u32 m0, s37, 42880
    s_nop 0
    buffer_load_dwordx4 v251, s[24:27], s78 offen offset:384 lds
    s_add_u32 m0, s37, 47104
    s_nop 0
    buffer_load_dwordx4 v251, s[24:27], s79 offen offset:384 lds
    s_waitcnt lgkmcnt(0)
    v_lshlrev_b32 v200, 16, v60
    v_and_b32 v204, s51, v60
    v_lshlrev_b32 v201, 16, v61
    v_and_b32 v205, s51, v61
    v_lshlrev_b32 v202, 16, v62
    v_and_b32 v206, s51, v62
    v_lshlrev_b32 v203, 16, v63
    v_and_b32 v207, s51, v63
    s_waitcnt vmcnt(11) lgkmcnt(0)
    s_barrier
    ds_read_b128 a[0:3], v248 offset:1024
    ds_read_b128 a[4:7], v248 offset:1280
    ds_read_b128 a[8:11], v248 offset:1536
    ds_read_b128 a[12:15], v248 offset:1792
    ds_read_b128 a[16:19], v248 offset:5248
    ds_read_b128 a[20:23], v248 offset:5504
    ds_read_b128 a[24:27], v248 offset:5760
    ds_read_b128 a[28:31], v248 offset:6016
    ds_read_b128 a[32:35], v248 offset:9472
    ds_read_b128 a[36:39], v248 offset:9728
    s_waitcnt lgkmcnt(9)
    v_mfma_f32_16x16x32_bf16 v[208:211], a[0:3], v[12:15], 0
    s_waitcnt lgkmcnt(8)
    ds_read_b128 a[40:43], v248 offset:9984
    v_mfma_f32_16x16x32_bf16 v[212:215], a[4:7], v[16:19], 0
    s_waitcnt vmcnt(8) lgkmcnt(6)
    ds_read_b128 a[44:47], v248 offset:10240
    v_mfma_f32_16x16x32_bf16 v[208:211], a[8:11], v[16:19], v[208:211]
    s_barrier
    ds_read_b128 a[0:3], v248 offset:13696
    v_mfma_f32_16x16x32_bf16 v[212:215], a[12:15], v[20:23], v[212:215]
    s_add_u32 m0, s37, 51200
    ds_read_b128 a[4:7], v248 offset:13952
    buffer_load_dwordx4 v251, s[24:27], s7 offen offset:512 lds
    v_mfma_f32_16x16x32_bf16 v[216:219], a[16:19], v[12:15], 0
    s_waitcnt lgkmcnt(8)
    ds_read_b128 a[8:11], v248 offset:14208
    v_mfma_f32_16x16x32_bf16 v[220:223], a[20:23], v[16:19], 0
    s_waitcnt lgkmcnt(7)
    ds_read_b128 a[12:15], v248 offset:14464
    v_mfma_f32_16x16x32_bf16 v[216:219], a[24:27], v[16:19], v[216:219]
    s_add_u32 m0, s37, 55424
    ds_read_b128 a[16:19], v248 offset:17920
    buffer_load_dwordx4 v251, s[24:27], s78 offen offset:512 lds
    v_mfma_f32_16x16x32_bf16 v[220:223], a[28:31], v[20:23], v[220:223]
    s_waitcnt lgkmcnt(8)
    ds_read_b128 a[20:23], v248 offset:18176
    v_mfma_f32_16x16x32_bf16 v[224:227], a[32:35], v[12:15], 0
    s_waitcnt lgkmcnt(7)
    ds_read_b128 a[24:27], v248 offset:18432
    v_mfma_f32_16x16x32_bf16 v[228:231], a[36:39], v[16:19], 0
    s_add_u32 m0, s37, 59648
    ds_read_b128 a[28:31], v248 offset:18688
    buffer_load_dwordx4 v251, s[24:27], s79 offen offset:512 lds
    v_mfma_f32_16x16x32_bf16 v[224:227], a[40:43], v[16:19], v[224:227]
    s_waitcnt lgkmcnt(8)
    ds_read_b128 a[32:35], v248 offset:22144
    v_mfma_f32_16x16x32_bf16 v[228:231], a[44:47], v[20:23], v[228:231]
    s_waitcnt lgkmcnt(7)
    ds_read_b128 a[36:39], v248 offset:22400
    v_mfma_f32_16x16x32_bf16 v[208:211], a[0:3], v[20:23], v[208:211]
    s_add_u32 m0, s38, 66560
    ds_read_b128 a[40:43], v248 offset:22656
    buffer_load_dwordx4 v252, s[8:11], m0 offen lds
    v_mfma_f32_16x16x32_bf16 v[212:215], a[4:7], v[24:27], v[212:215]
    s_waitcnt vmcnt(7) lgkmcnt(6)
    ds_read_b128 a[44:47], v248 offset:22912
    v_mfma_f32_16x16x32_bf16 v[208:211], a[8:11], v[24:27], v[208:211]
    s_barrier
    ds_read_b128 a[0:3], v248 offset:26368
    v_mfma_f32_16x16x32_bf16 v[212:215], a[12:15], v[28:31], v[212:215]
    s_add_u32 m0, s37, 384
    ds_read_b128 a[4:7], v248 offset:26624
    buffer_load_dwordx4 v251, s[24:27], s7 offen offset:640 lds
    v_mfma_f32_16x16x32_bf16 v[216:219], a[16:19], v[20:23], v[216:219]
    s_waitcnt lgkmcnt(8)
    ds_read_b128 a[8:11], v248 offset:26880
    v_mfma_f32_16x16x32_bf16 v[220:223], a[20:23], v[24:27], v[220:223]
    s_waitcnt lgkmcnt(7)
    ds_read_b128 a[12:15], v248 offset:27136
    v_mfma_f32_16x16x32_bf16 v[216:219], a[24:27], v[24:27], v[216:219]
    s_add_u32 m0, s37, 4608
    ds_read_b128 a[16:19], v248 offset:30592
    buffer_load_dwordx4 v251, s[24:27], s78 offen offset:640 lds
    v_mfma_f32_16x16x32_bf16 v[220:223], a[28:31], v[28:31], v[220:223]
    s_waitcnt lgkmcnt(8)
    ds_read_b128 a[20:23], v248 offset:30848
    v_mfma_f32_16x16x32_bf16 v[224:227], a[32:35], v[20:23], v[224:227]
    s_waitcnt lgkmcnt(7)
    ds_read_b128 a[24:27], v248 offset:31104
    v_mfma_f32_16x16x32_bf16 v[228:231], a[36:39], v[24:27], v[228:231]
    s_add_u32 m0, s37, 8832
    ds_read_b128 a[28:31], v248 offset:31360
    buffer_load_dwordx4 v251, s[24:27], s79 offen offset:640 lds
    v_mfma_f32_16x16x32_bf16 v[224:227], a[40:43], v[24:27], v[224:227]
    s_waitcnt lgkmcnt(8)
    ds_read_b128 a[32:35], v248 offset:34816
    v_mfma_f32_16x16x32_bf16 v[228:231], a[44:47], v[28:31], v[228:231]
    s_waitcnt lgkmcnt(7)
    ds_read_b128 a[36:39], v248 offset:35072
    v_mfma_f32_16x16x32_bf16 v[208:211], a[0:3], v[28:31], v[208:211]
    s_add_u32 m0, s38, 70656
    ds_read_b128 a[40:43], v248 offset:35328
    buffer_load_dwordx4 v252, s[8:11], m0 offen lds
    v_mfma_f32_16x16x32_bf16 v[212:215], a[4:7], v[32:35], v[212:215]
    s_waitcnt lgkmcnt(8)
    ds_read_b128 a[44:47], v248 offset:35584
    v_mfma_f32_16x16x32_bf16 v[208:211], a[8:11], v[32:35], v[208:211]
    s_waitcnt lgkmcnt(7)
    ds_read_b128 a[0:3], v254 offset:8192
    v_mfma_f32_16x16x32_bf16 v[212:215], a[12:15], v[36:39], v[212:215]
    s_add_u32 m0, s38, 74752
    ds_read_b128 a[4:7], v254 offset:8256
    buffer_load_dwordx4 v252, s[8:11], m0 offen lds
    v_mfma_f32_16x16x32_bf16 v[216:219], a[16:19], v[28:31], v[216:219]
    s_waitcnt vmcnt(9) lgkmcnt(6)
    ds_read_b128 a[8:11], v254 offset:8320
    v_mfma_f32_16x16x32_bf16 v[220:223], a[20:23], v[32:35], v[220:223]
    s_barrier
    ds_read_b128 a[12:15], v248 offset:39040
    v_mfma_f32_16x16x32_bf16 v[216:219], a[24:27], v[32:35], v[216:219]
    s_add_u32 m0, s37, 13696
    ds_read_b128 a[16:19], v248 offset:39296
    buffer_load_dwordx4 v99, s[24:27], 0 offen lds
    v_mfma_f32_16x16x32_bf16 v[220:223], a[28:31], v[36:39], v[220:223]
    s_waitcnt lgkmcnt(8)
    ds_read_b128 a[20:23], v248 offset:39552
    v_mfma_f32_16x16x32_bf16 v[224:227], a[32:35], v[28:31], v[224:227]
    s_waitcnt lgkmcnt(7)
    ds_read_b128 a[24:27], v248 offset:39808
    v_mfma_f32_16x16x32_bf16 v[228:231], a[36:39], v[32:35], v[228:231]
    s_add_u32 m0, s37, 17920
    ds_read_b128 a[28:31], v248 offset:43264
    buffer_load_dwordx4 v255, s[24:27], s7 offen lds
    v_mfma_f32_16x16x32_bf16 v[224:227], a[40:43], v[32:35], v[224:227]
    s_waitcnt lgkmcnt(8)
    ds_read_b128 a[32:35], v248 offset:43520
    v_mfma_f32_16x16x32_bf16 v[228:231], a[44:47], v[36:39], v[228:231]
    s_waitcnt lgkmcnt(7)
    ds_read_b128 a[36:39], v248 offset:43776
    v_mfma_f32_16x16x32_bf16 v[232:235], a[0:3], v[12:15], 0
    s_add_u32 m0, s37, 22144
    ds_read_b128 a[40:43], v248 offset:44032
    buffer_load_dwordx4 v255, s[24:27], s79 offen lds
    v_mfma_f32_16x16x32_bf16 v[232:235], a[4:7], v[16:19], v[232:235]
    s_waitcnt lgkmcnt(8)
    ds_read_b128 a[44:47], v248 offset:47488
    v_mfma_f32_16x16x32_bf16 v[232:235], a[8:11], v[20:23], v[232:235]
    s_waitcnt lgkmcnt(7)
    ds_read_b128 a[0:3], v248 offset:47744
    v_mfma_f32_16x16x32_bf16 v[208:211], a[12:15], v[36:39], v[208:211]
    s_add_u32 m0, s38, 78848
    ds_read_b128 a[4:7], v248 offset:48000
    buffer_load_dwordx4 v252, s[8:11], m0 offen lds
    v_mfma_f32_16x16x32_bf16 v[212:215], a[16:19], v[40:43], v[212:215]
    s_waitcnt lgkmcnt(8)
    ds_read_b128 a[8:11], v248 offset:48256
    v_mfma_f32_16x16x32_bf16 v[208:211], a[20:23], v[40:43], v[208:211]
    s_waitcnt lgkmcnt(7)
    ds_read_b128 a[12:15], v254 offset:8384
    v_mfma_f32_16x16x32_bf16 v[212:215], a[24:27], v[44:47], v[212:215]
    s_add_u32 m0, s38, 82944
    ds_read_b128 a[16:19], v254 offset:8448
    buffer_load_dwordx4 v252, s[8:11], m0 offen lds
    v_mfma_f32_16x16x32_bf16 v[216:219], a[28:31], v[36:39], v[216:219]
    s_waitcnt vmcnt(11) lgkmcnt(6)
    ds_read_b128 a[20:23], v254 offset:8512
    v_mfma_f32_16x16x32_bf16 v[220:223], a[32:35], v[40:43], v[220:223]
    s_barrier
    ds_read_b128 a[24:27], v248 offset:51712
    v_mfma_f32_16x16x32_bf16 v[216:219], a[36:39], v[40:43], v[216:219]
    s_add_u32 m0, s38, 87040
    ds_read_b128 a[28:31], v248 offset:51968
    buffer_load_dwordx4 v252, s[8:11], m0 offen lds
    v_mfma_f32_16x16x32_bf16 v[220:223], a[40:43], v[44:47], v[220:223]
    s_waitcnt lgkmcnt(8)
    ds_read_b128 a[32:35], v248 offset:52224
    v_mfma_f32_16x16x32_bf16 v[224:227], a[44:47], v[36:39], v[224:227]
    s_waitcnt lgkmcnt(7)
    ds_read_b128 a[36:39], v248 offset:52480
    v_mfma_f32_16x16x32_bf16 v[228:231], a[0:3], v[40:43], v[228:231]
    s_add_u32 m0, s38, 91136
    ds_read_b128 a[40:43], v248 offset:55936
    buffer_load_dwordx4 v252, s[8:11], m0 offen lds
    v_mfma_f32_16x16x32_bf16 v[224:227], a[4:7], v[40:43], v[224:227]
    s_waitcnt lgkmcnt(6)
    ds_read_b128 a[44:47], v248 offset:56192
    v_mfma_f32_16x16x32_bf16 v[228:231], a[8:11], v[44:47], v[228:231]
    s_add_u32 s39, s38, 166400
    ds_read_b128 a[0:3], v248 offset:56448
    v_mfma_f32_16x16x32_bf16 v[232:235], a[12:15], v[24:27], v[232:235]
    s_add_u32 m0, s38, 149504
    ds_read_b128 a[4:7], v248 offset:56704
    buffer_load_dwordx4 v252, s[24:27], s39 offen lds
    v_mfma_f32_16x16x32_bf16 v[232:235], a[16:19], v[28:31], v[232:235]
    s_waitcnt lgkmcnt(6)
    ds_read_b128 a[8:11], v248 offset:60160
    v_mfma_f32_16x16x32_bf16 v[232:235], a[20:23], v[32:35], v[232:235]
    s_add_u32 s39, s38, 170496
    ds_read_b128 a[12:15], v248 offset:60416
    v_mfma_f32_16x16x32_bf16 v[208:211], a[24:27], v[44:47], v[208:211]
    s_add_u32 m0, s38, 153600
    ds_read_b128 a[16:19], v248 offset:60672
    buffer_load_dwordx4 v252, s[24:27], s39 offen lds
    v_mfma_f32_16x16x32_bf16 v[212:215], a[28:31], v[48:51], v[212:215]
    s_waitcnt lgkmcnt(6)
    ds_read_b128 a[20:23], v248 offset:60928
    v_mfma_f32_16x16x32_bf16 v[208:211], a[32:35], v[48:51], v[208:211]
    s_mov_b32 s7, 86528
    ds_read_b128 a[24:27], v254 offset:8576
    v_mfma_f32_16x16x32_bf16 v[212:215], a[36:39], v[52:55], v[212:215]
    s_add_u32 m0, s37, 26368
    ds_read_b128 a[28:31], v254 offset:8640
    buffer_load_dwordx4 v251, s[24:27], s7 offen lds
    v_mfma_f32_16x16x32_bf16 v[216:219], a[40:43], v[44:47], v[216:219]
    s_waitcnt vmcnt(12) lgkmcnt(7)
    ds_read_b128 a[32:35], v254 offset:8704
    v_mfma_f32_16x16x32_bf16 v[220:223], a[44:47], v[48:51], v[220:223]
    s_barrier
    ds_read_b128 a[36:39], v248 offset:1024
    v_mfma_f32_16x16x32_bf16 v[216:219], a[0:3], v[48:51], v[216:219]
    s_waitcnt lgkmcnt(6)
    ds_read_b128 a[40:43], v248 offset:1280
    v_mfma_f32_16x16x32_bf16 v[220:223], a[4:7], v[52:55], v[220:223]
    s_mov_b32 s78, 113152
    ds_read_b128 a[44:47], v248 offset:1536
    v_mfma_f32_16x16x32_bf16 v[224:227], a[8:11], v[44:47], v[224:227]
    s_add_u32 m0, s37, 30592
    ds_read_b128 a[0:3], v248 offset:1792
    buffer_load_dwordx4 v251, s[24:27], s78 offen lds
    v_mfma_f32_16x16x32_bf16 v[228:231], a[12:15], v[48:51], v[228:231]
    s_waitcnt lgkmcnt(6)
    ds_read_b128 a[4:7], v248 offset:5248
    v_mfma_f32_16x16x32_bf16 v[224:227], a[16:19], v[48:51], v[224:227]
    s_mov_b32 s79, 139776
    ds_read_b128 a[8:11], v248 offset:5504
    v_mfma_f32_16x16x32_bf16 v[228:231], a[20:23], v[52:55], v[228:231]
    s_add_u32 m0, s37, 34816
    ds_read_b128 a[12:15], v248 offset:5760
    buffer_load_dwordx4 v251, s[24:27], s79 offen lds
    v_mfma_f32_16x16x32_bf16 v[232:235], a[24:27], v[36:39], v[232:235]
    s_waitcnt lgkmcnt(8)
    ds_read_b128 a[16:19], v248 offset:6016
    v_mfma_f32_16x16x32_bf16 v[232:235], a[28:31], v[40:43], v[232:235]
    s_waitcnt lgkmcnt(7)
    ds_read_b128 a[20:23], v248 offset:9472
    v_mfma_f32_16x16x32_bf16 v[232:235], a[32:35], v[44:47], v[232:235]
    s_add_u32 m0, s38, 95232
    ds_read_b128 a[24:27], v248 offset:9728
    buffer_load_dwordx4 v252, s[8:11], m0 offen lds
    v_mfma_f32_16x16x32_bf16 v[208:211], a[36:39], v[52:55], v[208:211]
    s_waitcnt lgkmcnt(8)
    ds_read_b128 a[28:31], v248 offset:9984
    v_mfma_f32_16x16x32_bf16 v[212:215], a[40:43], v[56:59], v[212:215]
    s_waitcnt lgkmcnt(7)
    ds_read_b128 a[32:35], v248 offset:10240
    v_mfma_f32_16x16x32_bf16 v[208:211], a[44:47], v[56:59], v[208:211]
    s_add_u32 m0, s38, 99328
    ds_read_b128 a[36:39], v254 offset:8768
    buffer_load_dwordx4 v252, s[8:11], m0 offen lds
    v_mfma_f32_16x16x32_bf16 v[212:215], a[0:3], v[60:63], v[212:215]
    s_waitcnt lgkmcnt(8)
    ds_read_b128 a[40:43], v254 offset:8832
    v_mfma_f32_16x16x32_bf16 v[216:219], a[4:7], v[52:55], v[216:219]
    s_waitcnt vmcnt(11) lgkmcnt(6)
    ds_read_b128 a[44:47], v254 offset:8896
    v_mfma_f32_16x16x32_bf16 v[220:223], a[8:11], v[56:59], v[220:223]
    s_barrier
    ds_read_b128 a[0:3], v248 offset:13696
    v_mfma_f32_16x16x32_bf16 v[216:219], a[12:15], v[56:59], v[216:219]
    s_add_u32 m0, s38, 103424
    ds_read_b128 a[4:7], v248 offset:17920
    buffer_load_dwordx4 v252, s[8:11], m0 offen lds
    v_mfma_f32_16x16x32_bf16 v[220:223], a[16:19], v[60:63], v[220:223]
    s_waitcnt lgkmcnt(8)
    ds_read_b128 a[8:11], v248 offset:13952
    v_mfma_f32_16x16x32_bf16 v[224:227], a[20:23], v[52:55], v[224:227]
    s_waitcnt lgkmcnt(7)
    ds_read_b128 a[12:15], v248 offset:18432
    v_mfma_f32_16x16x32_bf16 v[228:231], a[24:27], v[56:59], v[228:231]
    s_add_u32 m0, s37, 38912
    ds_read_b128 a[16:19], v248 offset:14208
    buffer_load_dwordx4 v251, s[24:27], s7 offen offset:128 lds
    v_mfma_f32_16x16x32_bf16 v[224:227], a[28:31], v[56:59], v[224:227]
    s_waitcnt lgkmcnt(8)
    ds_read_b128 a[20:23], v248 offset:22144
    v_mfma_f32_16x16x32_bf16 v[228:231], a[32:35], v[60:63], v[228:231]
    s_waitcnt vmcnt(12) lgkmcnt(6)
    ds_read_b128 a[24:27], v254 offset:8960
    v_mfma_f32_16x16x32_bf16 v[232:235], a[36:39], v[48:51], v[232:235]
    s_barrier
    ds_read_b128 a[28:31], v249 offset:0
    v_mfma_f32_16x16x32_bf16 v[232:235], a[40:43], v[52:55], v[232:235]
    s_add_u32 m0, s37, 43136
    ds_read_b128 a[32:35], v249 offset:208
    buffer_load_dwordx4 v251, s[24:27], s78 offen offset:128 lds
    v_mfma_f32_16x16x32_bf16 v[232:235], a[44:47], v[56:59], v[232:235]
    s_waitcnt lgkmcnt(8)
    ds_read_b128 a[36:39], v249 offset:6656
    v_mfma_f32_16x16x32_bf16 v[212:215], a[0:3], v[12:15], v[212:215]
    s_waitcnt lgkmcnt(7)
    ds_read_b128 a[40:43], v249 offset:6864
    v_mfma_f32_16x16x32_bf16 v[208:211], a[4:7], v[60:63], v[208:211]
    s_add_u32 m0, s37, 47360
    ds_read_b128 a[44:47], v249 offset:64
    buffer_load_dwordx4 v251, s[24:27], s79 offen offset:128 lds
    v_mfma_f32_16x16x32_bf16 v[220:223], a[8:11], v[12:15], v[220:223]
    s_waitcnt lgkmcnt(8)
    ds_read_b128 a[0:3], v249 offset:272
    v_mfma_f32_16x16x32_bf16 v[216:219], a[12:15], v[60:63], v[216:219]
    s_waitcnt lgkmcnt(7)
    ds_read_b128 a[4:7], v249 offset:6720
    v_cvt_pk_bf16_f32 v208, v208, v212
    v_cvt_pk_bf16_f32 v209, v209, v213
    v_cvt_pk_bf16_f32 v210, v210, v214
    v_mfma_f32_16x16x32_bf16 v[228:231], a[16:19], v[12:15], v[228:231]
    s_add_u32 m0, s38, 107520
    ds_read_b128 a[8:11], v249 offset:6928
    buffer_load_dwordx4 v252, s[8:11], m0 offen lds
    v_cvt_pk_bf16_f32 v211, v211, v215
    v_accvgpr_write_b32 a100, v208
    v_mfma_f32_16x16x32_bf16 v[224:227], a[20:23], v[60:63], v[224:227]
    s_waitcnt lgkmcnt(8)
    ds_read_b128 a[12:15], v249 offset:128
    v_accvgpr_write_b32 a101, v209
    v_accvgpr_write_b32 a102, v210
    v_accvgpr_write_b32 a103, v211
    v_mfma_f32_16x16x32_bf16 v[232:235], a[24:27], v[60:63], v[232:235]
    s_waitcnt lgkmcnt(7)
    ds_read_b128 a[16:19], v249 offset:336
    v_cvt_pk_bf16_f32 v216, v216, v220
    v_cvt_pk_bf16_f32 v217, v217, v221
    v_mfma_f32_16x16x32_bf16 v[0:3], a[28:31], a[100:103], 1.0
    s_add_u32 m0, s38, 111616
    ds_read_b128 a[20:23], v249 offset:6784
    buffer_load_dwordx4 v252, s[8:11], m0 offen lds
    v_cvt_pk_bf16_f32 v218, v218, v222
    v_cvt_pk_bf16_f32 v219, v219, v223
    v_mfma_f32_16x16x32_bf16 v[4:7], a[32:35], a[100:103], 1.0
    s_waitcnt lgkmcnt(8)
    ds_read_b128 a[24:27], v249 offset:6992
    v_accvgpr_write_b32 a104, v216
    v_accvgpr_write_b32 a105, v217
    v_mfma_f32_16x16x32_bf16 v[8:11], a[36:39], a[100:103], 1.0
    s_waitcnt lgkmcnt(8)
    ds_read_b64 a[48:49], v250 offset:0
    v_accvgpr_write_b32 a106, v218
    v_accvgpr_write_b32 a107, v219
    v_mfma_f32_16x16x32_bf16 v[12:15], a[40:43], a[100:103], 1.0
    s_waitcnt lgkmcnt(7)
    v_cvt_pk_bf16_f32 v224, v224, v228
    v_cvt_pk_bf16_f32 v225, v225, v229
    v_mfma_f32_16x16x32_bf16 v[0:3], a[44:47], a[104:107], v[0:3]
    s_add_u32 m0, s38, 115712
    ds_read_b64 a[52:53], v250 offset:6656
    buffer_load_dwordx4 v252, s[8:11], m0 offen lds
    v_cvt_pk_bf16_f32 v226, v226, v230
    v_cvt_pk_bf16_f32 v227, v227, v231
    v_mfma_f32_16x16x32_bf16 v[4:7], a[0:3], a[104:107], v[4:7]
    s_waitcnt vmcnt(14) lgkmcnt(5)
    v_accvgpr_write_b32 a108, v224
    v_accvgpr_write_b32 a109, v225
    v_mfma_f32_16x16x32_bf16 v[8:11], a[4:7], a[104:107], v[8:11]
    s_barrier
    ds_read_b128 a[28:31], v249 offset:13312
    v_accvgpr_write_b32 a110, v226
    v_accvgpr_write_b32 a111, v227
    v_mfma_f32_16x16x32_bf16 v[12:15], a[8:11], a[104:107], v[12:15]
    s_add_u32 m0, s37, 51456
    ds_read_b128 a[32:35], v249 offset:13520
    buffer_load_dwordx4 v251, s[24:27], s7 offen offset:256 lds
    v_mfma_f32_16x16x32_bf16 v[0:3], a[12:15], a[108:111], v[0:3]
    s_waitcnt lgkmcnt(6)
    ds_read_b128 a[36:39], v249 offset:13376
    v_cvt_pk_bf16_f32 v232, v232, v233
    v_cvt_pk_bf16_f32 v233, v234, v235
    v_mfma_f32_16x16x32_bf16 v[4:7], a[16:19], a[108:111], v[4:7]
    s_waitcnt lgkmcnt(5)
    ds_read_b128 a[40:43], v249 offset:13584
    v_cndmask_b32 v234, 0, v232, s[40:41]
    v_cndmask_b32 v235, 0, v233, s[40:41]
    v_mfma_f32_16x16x32_bf16 v[8:11], a[20:23], a[108:111], v[8:11]
    s_add_u32 m0, s37, 55680
    ds_read_b128 a[44:47], v249 offset:13440
    buffer_load_dwordx4 v251, s[24:27], s78 offen offset:256 lds
    v_accvgpr_write_b32 a112, v234
    v_accvgpr_write_b32 a113, v235
    v_mfma_f32_16x16x32_bf16 v[12:15], a[24:27], a[108:111], v[12:15]
    s_waitcnt lgkmcnt(6)
    ds_read_b128 a[0:3], v249 offset:13648
    v_cndmask_b32 v232, v232, 0, s[40:41]
    v_cndmask_b32 v233, v233, 0, s[40:41]
    v_accvgpr_write_b32 a116, v232
    v_accvgpr_write_b32 a117, v233
    v_mfma_f32_16x16x32_bf16 v[0:3], a[48:51], a[112:115], v[0:3]
    ds_read_b64 a[56:57], v250 offset:13312
    v_mfma_f32_16x16x32_bf16 v[4:7], a[48:51], a[116:119], v[4:7]
    s_waitcnt lgkmcnt(7)
    v_mfma_f32_16x16x32_bf16 v[8:11], a[52:55], a[112:115], v[8:11]
    s_add_u32 m0, s37, 59904
    ds_read_b128 a[4:7], v249 offset:19968
    buffer_load_dwordx4 v251, s[24:27], s79 offen offset:256 lds
    v_mfma_f32_16x16x32_bf16 v[12:15], a[52:55], a[116:119], v[12:15]
    s_waitcnt lgkmcnt(7)
    ds_read_b128 a[8:11], v248 offset:18176
    v_mul_f32 v236, v104, v0
    v_mfma_f32_16x16x32_bf16 v[16:19], a[28:31], a[100:103], 1.0
    s_waitcnt lgkmcnt(7)
    ds_read_b128 a[12:15], v249 offset:20176
    v_mul_f32 v244, v108, v4
    v_mfma_f32_16x16x32_bf16 v[20:23], a[32:35], a[100:103], 1.0
    s_waitcnt lgkmcnt(6)
    ds_read_b128 a[16:19], v248 offset:18688
    v_cvt_pk_bf16_f32 v236, v236, v244
    v_mfma_f32_16x16x32_bf16 v[16:19], a[36:39], a[104:107], v[16:19]
    s_add_u32 m0, s38, 119808
    ds_read_b128 a[20:23], v249 offset:20032
    buffer_load_dwordx4 v252, s[8:11], m0 offen lds
    v_mfma_f32_16x16x32_bf16 v[20:23], a[40:43], a[104:107], v[20:23]
    s_waitcnt lgkmcnt(7)
    ds_read_b128 a[24:27], v248 offset:22400
    v_mul_f32 v237, v105, v1
    v_mfma_f32_16x16x32_bf16 v[16:19], a[44:47], a[108:111], v[16:19]
    s_waitcnt vmcnt(11) lgkmcnt(6)
    ds_read_b128 a[28:31], v249 offset:20240
    v_mul_f32 v245, v109, v5
    v_cvt_pk_bf16_f32 v237, v237, v245
    v_mfma_f32_16x16x32_bf16 v[20:23], a[0:3], a[108:111], v[20:23]
    s_barrier
    ds_read_b128 a[32:35], v254 offset:16384
    v_mul_f32 v238, v106, v2
    v_mul_f32 v244, v110, v6
    v_mfma_f32_16x16x32_bf16 v[16:19], a[56:59], a[112:115], v[16:19]
    s_add_u32 m0, s38, 123904
    ds_read_b128 a[36:39], v249 offset:20096
    buffer_load_dwordx4 v252, s[8:11], m0 offen lds
    v_cvt_pk_bf16_f32 v238, v238, v244
    v_mul_f32 v239, v107, v3
    v_mfma_f32_16x16x32_bf16 v[20:23], a[56:59], a[116:119], v[20:23]
    s_waitcnt lgkmcnt(8)
    ds_read_b128 a[40:43], v248 offset:26368
    v_mul_f32 v245, v111, v7
    v_cvt_pk_bf16_f32 v239, v239, v245
    v_mfma_f32_16x16x32_bf16 v[24:27], a[4:7], a[100:103], 1.0
    s_waitcnt lgkmcnt(8)
    ds_read_b128 a[44:47], v249 offset:20304
    v_mul_f32 v240, v112, v8
    v_mfma_f32_16x16x32_bf16 v[212:215], a[8:11], v[236:239], 0
    s_waitcnt lgkmcnt(7)
    ds_read_b128 a[0:3], v248 offset:30592
    v_mul_f32 v244, v116, v12
    v_mfma_f32_16x16x32_bf16 v[28:31], a[12:15], a[100:103], 1.0
    s_add_u32 m0, s38, 128000
    ds_read_b64 a[60:61], v250 offset:19968
    buffer_load_dwordx4 v252, s[8:11], m0 offen lds
    v_mfma_f32_16x16x32_bf16 v[220:223], a[16:19], v[236:239], 0
    s_waitcnt lgkmcnt(8)
    ds_read_b128 a[4:7], v248 offset:34816
    v_cvt_pk_bf16_f32 v240, v240, v244
    v_mfma_f32_16x16x32_bf16 v[24:27], a[20:23], a[104:107], v[24:27]
    s_waitcnt lgkmcnt(6)
    v_mul_f32 v241, v113, v9
    v_mul_f32 v245, v117, v13
    v_mfma_f32_16x16x32_bf16 v[228:231], a[24:27], v[236:239], 0
    s_add_u32 s39, s38, 132096
    ds_read_b128 a[8:11], v249 offset:26624
    v_cvt_pk_bf16_f32 v241, v241, v245
    v_mfma_f32_16x16x32_bf16 v[28:31], a[28:31], a[104:107], v[28:31]
    s_mov_b32 m0, s48
    ds_read_b128 a[12:15], v248 offset:26624
    buffer_load_dwordx4 v252, s[8:11], s39 offen lds
    v_mfma_f32_16x16x32_bf16 v[232:235], a[32:35], v[236:239], 0
    s_waitcnt lgkmcnt(7)
    ds_read_b128 a[16:19], v249 offset:26832
    v_mul_f32 v242, v114, v10
    v_mfma_f32_16x16x32_bf16 v[24:27], a[36:39], a[108:111], v[24:27]
    s_waitcnt lgkmcnt(7)
    ds_read_b128 a[20:23], v248 offset:26880
    v_mul_f32 v244, v118, v14
    v_mfma_f32_16x16x32_bf16 v[208:211], a[40:43], v[236:239], 0
    s_waitcnt lgkmcnt(6)
    ds_read_b128 a[24:27], v249 offset:26688
    v_cvt_pk_bf16_f32 v242, v242, v244
    v_mfma_f32_16x16x32_bf16 v[28:31], a[44:47], a[108:111], v[28:31]
    s_add_u32 m0, s37, 640
    ds_read_b128 a[28:31], v248 offset:30848
    buffer_load_dwordx4 v251, s[24:27], s7 offen offset:384 lds
    v_mfma_f32_16x16x32_bf16 v[216:219], a[0:3], v[236:239], 0
    s_waitcnt lgkmcnt(7)
    ds_read_b128 a[32:35], v249 offset:26896
    v_mul_f32 v243, v115, v11
    v_mfma_f32_16x16x32_bf16 v[24:27], a[60:63], a[112:115], v[24:27]
    s_waitcnt lgkmcnt(7)
    ds_read_b128 a[36:39], v248 offset:31104
    v_mul_f32 v245, v119, v15
    v_mfma_f32_16x16x32_bf16 v[224:227], a[4:7], v[236:239], 0
    s_waitcnt lgkmcnt(7)
    ds_read_b128 a[40:43], v249 offset:26752
    v_cvt_pk_bf16_f32 v243, v243, v245
    v_mfma_f32_16x16x32_bf16 v[28:31], a[60:63], a[116:119], v[28:31]
    s_add_u32 m0, s37, 4864
    ds_read_b128 a[44:47], v248 offset:35072
    buffer_load_dwordx4 v251, s[24:27], s78 offen offset:384 lds
    v_mfma_f32_16x16x32_bf16 v[32:35], a[8:11], a[100:103], 1.0
    s_waitcnt lgkmcnt(8)
    ds_read_b128 a[0:3], v249 offset:26960
    v_mul_f32 v236, v120, v16
    v_mfma_f32_16x16x32_bf16 v[212:215], a[12:15], v[240:243], v[212:215]
    s_waitcnt lgkmcnt(8)
    ds_read_b128 a[4:7], v248 offset:35328
    v_mul_f32 v244, v124, v20
    v_mfma_f32_16x16x32_bf16 v[36:39], a[16:19], a[100:103], 1.0
    s_waitcnt lgkmcnt(7)
    ds_read_b64 a[64:65], v250 offset:26624
    v_cvt_pk_bf16_f32 v236, v236, v244
    v_mfma_f32_16x16x32_bf16 v[208:211], a[20:23], v[240:243], v[208:211]
    s_add_u32 m0, s37, 9088
    ds_read_b128 a[8:11], v254 offset:16448
    buffer_load_dwordx4 v251, s[24:27], s79 offen offset:384 lds
    v_mfma_f32_16x16x32_bf16 v[32:35], a[24:27], a[104:107], v[32:35]
    s_waitcnt vmcnt(13) lgkmcnt(7)
    v_mul_f32 v237, v121, v17
    v_mul_f32 v245, v125, v21
    v_mfma_f32_16x16x32_bf16 v[220:223], a[28:31], v[240:243], v[220:223]
    s_barrier
    ds_read_b128 a[12:15], v249 offset:33280
    v_cvt_pk_bf16_f32 v237, v237, v245
    v_mfma_f32_16x16x32_bf16 v[36:39], a[32:35], a[104:107], v[36:39]
    s_waitcnt lgkmcnt(6)
    ds_read_b128 a[16:19], v248 offset:27136
    v_mul_f32 v238, v122, v18
    v_mfma_f32_16x16x32_bf16 v[216:219], a[36:39], v[240:243], v[216:219]
    s_add_u32 m0, s38, 69632
    ds_read_b128 a[20:23], v249 offset:33488
    buffer_load_dwordx4 v252, s[12:15], m0 offen lds
    v_mfma_f32_16x16x32_bf16 v[32:35], a[40:43], a[108:111], v[32:35]
    s_waitcnt lgkmcnt(7)
    ds_read_b128 a[24:27], v248 offset:31360
    v_mul_f32 v244, v126, v22
    v_mfma_f32_16x16x32_bf16 v[228:231], a[44:47], v[240:243], v[228:231]
    s_waitcnt lgkmcnt(7)
    ds_read_b128 a[28:31], v249 offset:33344
    v_cvt_pk_bf16_f32 v238, v238, v244
    v_mfma_f32_16x16x32_bf16 v[36:39], a[0:3], a[108:111], v[36:39]
    s_waitcnt lgkmcnt(6)
    ds_read_b128 a[32:35], v248 offset:35584
    v_mul_f32 v239, v123, v19
    v_mfma_f32_16x16x32_bf16 v[224:227], a[4:7], v[240:243], v[224:227]
    s_add_u32 m0, s38, 73728
    ds_read_b128 a[36:39], v249 offset:33552
    buffer_load_dwordx4 v252, s[12:15], m0 offen lds
    v_mfma_f32_16x16x32_bf16 v[32:35], a[64:67], a[112:115], v[32:35]
    s_waitcnt lgkmcnt(7)
    ds_read_b128 a[40:43], v254 offset:16512
    v_mul_f32 v245, v127, v23
    v_mfma_f32_16x16x32_bf16 v[232:235], a[8:11], v[240:243], v[232:235]
    ds_read_b128 a[44:47], v249 offset:33408
    v_cvt_pk_bf16_f32 v239, v239, v245
    v_mfma_f32_16x16x32_bf16 v[36:39], a[64:67], a[116:119], v[36:39]
    s_waitcnt lgkmcnt(7)
    ds_read_b128 a[0:3], v248 offset:39040
    v_mul_f32 v240, v128, v24
    v_mfma_f32_16x16x32_bf16 v[40:43], a[12:15], a[100:103], 1.0
    s_add_u32 m0, s38, 77824
    ds_read_b128 a[4:7], v249 offset:33616
    buffer_load_dwordx4 v252, s[12:15], m0 offen lds
    v_mfma_f32_16x16x32_bf16 v[212:215], a[16:19], v[236:239], v[212:215]
    s_waitcnt lgkmcnt(8)
    ds_read_b128 a[8:11], v248 offset:43264
    v_mul_f32 v244, v132, v28
    v_mfma_f32_16x16x32_bf16 v[44:47], a[20:23], a[100:103], 1.0
    s_waitcnt lgkmcnt(8)
    ds_read_b64 a[68:69], v250 offset:33280
    v_cvt_pk_bf16_f32 v240, v240, v244
    v_mfma_f32_16x16x32_bf16 v[220:223], a[24:27], v[236:239], v[220:223]
    s_waitcnt lgkmcnt(8)
    ds_read_b128 a[12:15], v248 offset:47488
    v_mul_f32 v241, v129, v25
    v_mfma_f32_16x16x32_bf16 v[40:43], a[28:31], a[104:107], v[40:43]
    s_waitcnt vmcnt(13) lgkmcnt(6)
    v_mul_f32 v245, v133, v29
    v_cvt_pk_bf16_f32 v241, v241, v245
    v_mfma_f32_16x16x32_bf16 v[228:231], a[32:35], v[236:239], v[228:231]
    s_barrier
    ds_read_b128 a[16:19], v249 offset:39936
    v_mul_f32 v242, v130, v26
    v_mfma_f32_16x16x32_bf16 v[44:47], a[36:39], a[104:107], v[44:47]
    s_add_u32 m0, s37, 13184
    ds_read_b128 a[20:23], v248 offset:39296
    buffer_load_dwordx4 v251, s[24:27], s7 offen offset:512 lds
    v_mfma_f32_16x16x32_bf16 v[232:235], a[40:43], v[236:239], v[232:235]
    s_waitcnt lgkmcnt(7)
    ds_read_b128 a[24:27], v249 offset:40144
    v_mul_f32 v244, v134, v30
    v_mfma_f32_16x16x32_bf16 v[40:43], a[44:47], a[108:111], v[40:43]
    s_waitcnt lgkmcnt(7)
    ds_read_b128 a[28:31], v248 offset:39552
    v_cvt_pk_bf16_f32 v242, v242, v244
    v_mfma_f32_16x16x32_bf16 v[208:211], a[0:3], v[236:239], v[208:211]
    s_waitcnt lgkmcnt(6)
    ds_read_b128 a[32:35], v249 offset:40000
    v_mul_f32 v243, v131, v27
    v_mfma_f32_16x16x32_bf16 v[44:47], a[4:7], a[108:111], v[44:47]
    s_add_u32 m0, s37, 17408
    ds_read_b128 a[36:39], v248 offset:43520
    buffer_load_dwordx4 v251, s[24:27], s78 offen offset:512 lds
    v_mfma_f32_16x16x32_bf16 v[216:219], a[8:11], v[236:239], v[216:219]
    s_waitcnt lgkmcnt(7)
    ds_read_b128 a[40:43], v249 offset:40208
    v_mul_f32 v245, v135, v31
    v_mfma_f32_16x16x32_bf16 v[40:43], a[68:71], a[112:115], v[40:43]
    s_waitcnt lgkmcnt(7)
    ds_read_b128 a[44:47], v248 offset:43776
    v_cvt_pk_bf16_f32 v243, v243, v245
    v_mfma_f32_16x16x32_bf16 v[224:227], a[12:15], v[236:239], v[224:227]
    s_waitcnt lgkmcnt(7)
    ds_read_b128 a[0:3], v249 offset:40064
    v_mul_f32 v236, v136, v32
    v_mfma_f32_16x16x32_bf16 v[44:47], a[68:71], a[116:119], v[44:47]
    s_add_u32 m0, s37, 21632
    ds_read_b128 a[4:7], v248 offset:47744
    buffer_load_dwordx4 v251, s[24:27], s79 offen offset:512 lds
    v_mfma_f32_16x16x32_bf16 v[48:51], a[16:19], a[100:103], 1.0
    s_waitcnt lgkmcnt(8)
    ds_read_b128 a[8:11], v249 offset:40272
    v_mul_f32 v244, v140, v36
    v_mfma_f32_16x16x32_bf16 v[212:215], a[20:23], v[240:243], v[212:215]
    s_waitcnt lgkmcnt(8)
    ds_read_b128 a[12:15], v248 offset:48000
    v_cvt_pk_bf16_f32 v236, v236, v244
    v_mfma_f32_16x16x32_bf16 v[52:55], a[24:27], a[100:103], 1.0
    s_waitcnt lgkmcnt(7)
    ds_read_b64 a[72:73], v250 offset:39936
    v_mul_f32 v237, v137, v33
    v_mfma_f32_16x16x32_bf16 v[208:211], a[28:31], v[240:243], v[208:211]
    s_add_u32 m0, s38, 81920
    ds_read_b128 a[16:19], v254 offset:16576
    buffer_load_dwordx4 v252, s[12:15], m0 offen lds
    v_mfma_f32_16x16x32_bf16 v[48:51], a[32:35], a[104:107], v[48:51]
    s_waitcnt lgkmcnt(8)
    v_mul_f32 v245, v141, v37
    v_cvt_pk_bf16_f32 v237, v237, v245
    v_mfma_f32_16x16x32_bf16 v[220:223], a[36:39], v[240:243], v[220:223]
    s_waitcnt lgkmcnt(7)
    ds_read_b128 a[20:23], v249 offset:46592
    v_mul_f32 v238, v138, v34
    v_mfma_f32_16x16x32_bf16 v[52:55], a[40:43], a[104:107], v[52:55]
    s_waitcnt lgkmcnt(6)
    ds_read_b128 a[24:27], v248 offset:39808
    v_mul_f32 v244, v142, v38
    v_mfma_f32_16x16x32_bf16 v[216:219], a[44:47], v[240:243], v[216:219]
    s_add_u32 m0, s38, 86016
    ds_read_b128 a[28:31], v249 offset:46800
    buffer_load_dwordx4 v252, s[12:15], m0 offen lds
    v_mfma_f32_16x16x32_bf16 v[48:51], a[0:3], a[108:111], v[48:51]
    s_waitcnt lgkmcnt(7)
    ds_read_b128 a[32:35], v248 offset:44032
    v_cvt_pk_bf16_f32 v238, v238, v244
    v_mfma_f32_16x16x32_bf16 v[228:231], a[4:7], v[240:243], v[228:231]
    s_waitcnt lgkmcnt(7)
    ds_read_b128 a[36:39], v249 offset:46656
    v_mul_f32 v239, v139, v35
    v_mfma_f32_16x16x32_bf16 v[52:55], a[8:11], a[108:111], v[52:55]
    s_waitcnt lgkmcnt(6)
    ds_read_b128 a[40:43], v248 offset:48256
    v_mul_f32 v245, v143, v39
    v_mfma_f32_16x16x32_bf16 v[224:227], a[12:15], v[240:243], v[224:227]
    s_add_u32 m0, s37, 25728
    ds_read_b128 a[44:47], v249 offset:46864
    buffer_load_dwordx4 v251, s[24:27], s7 offen offset:640 lds
    v_mfma_f32_16x16x32_bf16 v[48:51], a[72:75], a[112:115], v[48:51]
    s_waitcnt lgkmcnt(7)
    ds_read_b128 a[0:3], v254 offset:16640
    v_cvt_pk_bf16_f32 v239, v239, v245
    v_mfma_f32_16x16x32_bf16 v[232:235], a[16:19], v[240:243], v[232:235]
    s_waitcnt vmcnt(12) lgkmcnt(6)
    ds_read_b128 a[4:7], v249 offset:46720
    v_mul_f32 v240, v144, v40
    v_mfma_f32_16x16x32_bf16 v[52:55], a[72:75], a[116:119], v[52:55]
    s_barrier
    ds_read_b128 a[8:11], v248 offset:51712
    v_mul_f32 v244, v148, v44
    v_mfma_f32_16x16x32_bf16 v[56:59], a[20:23], a[100:103], 1.0
    s_add_u32 m0, s37, 29952
    ds_read_b128 a[12:15], v249 offset:46928
    buffer_load_dwordx4 v251, s[24:27], s78 offen offset:640 lds
    v_mfma_f32_16x16x32_bf16 v[212:215], a[24:27], v[236:239], v[212:215]
    s_waitcnt lgkmcnt(8)
    ds_read_b128 a[16:19], v248 offset:55936
    v_cvt_pk_bf16_f32 v240, v240, v244
    v_mfma_f32_16x16x32_bf16 v[60:63], a[28:31], a[100:103], 1.0
    s_waitcnt lgkmcnt(8)
    ds_read_b64 a[76:77], v250 offset:46592
    v_mul_f32 v241, v145, v41
    v_mfma_f32_16x16x32_bf16 v[220:223], a[32:35], v[236:239], v[220:223]
    s_waitcnt lgkmcnt(8)
    ds_read_b128 a[20:23], v248 offset:60160
    v_mul_f32 v245, v149, v45
    v_mfma_f32_16x16x32_bf16 v[56:59], a[36:39], a[104:107], v[56:59]
    s_waitcnt lgkmcnt(7)
    v_cvt_pk_bf16_f32 v241, v241, v245
    v_mul_f32 v242, v146, v42
    v_mfma_f32_16x16x32_bf16 v[228:231], a[40:43], v[236:239], v[228:231]
    s_add_u32 m0, s37, 34176
    ds_read_b128 a[24:27], v249 offset:53248
    buffer_load_dwordx4 v251, s[24:27], s79 offen offset:640 lds
    v_mfma_f32_16x16x32_bf16 v[60:63], a[44:47], a[104:107], v[60:63]
    s_waitcnt lgkmcnt(7)
    ds_read_b128 a[28:31], v248 offset:51968
    v_mul_f32 v244, v150, v46
    v_mfma_f32_16x16x32_bf16 v[232:235], a[0:3], v[236:239], v[232:235]
    s_waitcnt lgkmcnt(7)
    ds_read_b128 a[32:35], v249 offset:53456
    v_cvt_pk_bf16_f32 v242, v242, v244
    v_mfma_f32_16x16x32_bf16 v[56:59], a[4:7], a[108:111], v[56:59]
    s_waitcnt lgkmcnt(6)
    ds_read_b128 a[36:39], v248 offset:52224
    v_mul_f32 v243, v147, v43
    v_mfma_f32_16x16x32_bf16 v[208:211], a[8:11], v[236:239], v[208:211]
    s_add_u32 m0, s38, 90112
    ds_read_b128 a[40:43], v249 offset:53312
    buffer_load_dwordx4 v252, s[12:15], m0 offen lds
    v_mfma_f32_16x16x32_bf16 v[60:63], a[12:15], a[108:111], v[60:63]
    s_waitcnt lgkmcnt(7)
    ds_read_b128 a[44:47], v248 offset:56192
    v_mul_f32 v245, v151, v47
    v_mfma_f32_16x16x32_bf16 v[216:219], a[16:19], v[236:239], v[216:219]
    s_waitcnt lgkmcnt(7)
    ds_read_b128 a[0:3], v249 offset:53520
    v_cvt_pk_bf16_f32 v243, v243, v245
    v_mfma_f32_16x16x32_bf16 v[56:59], a[76:79], a[112:115], v[56:59]
    s_waitcnt lgkmcnt(7)
    ds_read_b128 a[4:7], v248 offset:56448
    v_mfma_f32_16x16x32_bf16 v[224:227], a[20:23], v[236:239], v[224:227]
    s_add_u32 m0, s38, 94208
    ds_read_b128 a[8:11], v249 offset:53376
    buffer_load_dwordx4 v252, s[12:15], m0 offen lds
    v_mfma_f32_16x16x32_bf16 v[60:63], a[76:79], a[116:119], v[60:63]
    s_waitcnt lgkmcnt(8)
    ds_read_b128 a[12:15], v248 offset:60416
    v_mul_f32 v236, v152, v48
    v_mfma_f32_16x16x32_bf16 v[64:67], a[24:27], a[100:103], 1.0
    s_waitcnt lgkmcnt(8)
    ds_read_b128 a[16:19], v249 offset:53584
    v_mul_f32 v244, v156, v52
    v_mfma_f32_16x16x32_bf16 v[212:215], a[28:31], v[240:243], v[212:215]
    s_waitcnt lgkmcnt(7)
    ds_read_b128 a[20:23], v248 offset:60672
    v_cvt_pk_bf16_f32 v236, v236, v244
    v_mfma_f32_16x16x32_bf16 v[68:71], a[32:35], a[100:103], 1.0
    s_add_u32 m0, s38, 98304
    ds_read_b64 a[80:81], v250 offset:53248
    buffer_load_dwordx4 v252, s[12:15], m0 offen lds
    v_mfma_f32_16x16x32_bf16 v[208:211], a[36:39], v[240:243], v[208:211]
    s_waitcnt lgkmcnt(8)
    ds_read_b128 a[24:27], v254 offset:16704
    v_mul_f32 v237, v153, v49
    v_mfma_f32_16x16x32_bf16 v[64:67], a[40:43], a[104:107], v[64:67]
    s_waitcnt lgkmcnt(8)
    v_mul_f32 v245, v157, v53
    v_cvt_pk_bf16_f32 v237, v237, v245
    v_mfma_f32_16x16x32_bf16 v[220:223], a[44:47], v[240:243], v[220:223]
    s_waitcnt lgkmcnt(6)
    ds_read_b128 a[28:31], v249 offset:59904
    v_mul_f32 v238, v154, v50
    v_mfma_f32_16x16x32_bf16 v[68:71], a[0:3], a[104:107], v[68:71]
    s_add_u32 m0, s38, 102400
    ds_read_b128 a[32:35], v248 offset:52480
    buffer_load_dwordx4 v252, s[12:15], m0 offen lds
    v_mfma_f32_16x16x32_bf16 v[216:219], a[4:7], v[240:243], v[216:219]
    s_waitcnt lgkmcnt(7)
    ds_read_b128 a[36:39], v249 offset:60112
    v_mul_f32 v244, v158, v54
    v_mfma_f32_16x16x32_bf16 v[64:67], a[8:11], a[108:111], v[64:67]
    s_waitcnt lgkmcnt(7)
    ds_read_b128 a[40:43], v248 offset:56704
    v_cvt_pk_bf16_f32 v238, v238, v244
    v_mfma_f32_16x16x32_bf16 v[228:231], a[12:15], v[240:243], v[228:231]
    s_waitcnt lgkmcnt(7)
    ds_read_b128 a[44:47], v249 offset:59968
    v_mul_f32 v239, v155, v51
    v_mfma_f32_16x16x32_bf16 v[68:71], a[16:19], a[108:111], v[68:71]
    s_waitcnt lgkmcnt(7)
    ds_read_b128 a[0:3], v248 offset:60928
    buffer_load_dword a138, v101, s[52:55], s86 offen
    v_mfma_f32_16x16x32_bf16 v[224:227], a[20:23], v[240:243], v[224:227]
    s_waitcnt lgkmcnt(6)
    ds_read_b128 a[4:7], v249 offset:60176
    v_mul_f32 v245, v159, v55
    v_mfma_f32_16x16x32_bf16 v[64:67], a[80:83], a[112:115], v[64:67]
    s_add_u32 m0, s38, 106496
    ds_read_b128 a[8:11], v254 offset:16768
    buffer_load_dwordx4 v252, s[12:15], m0 offen lds
    v_mfma_f32_16x16x32_bf16 v[232:235], a[24:27], v[240:243], v[232:235]
    s_waitcnt vmcnt(14) lgkmcnt(7)
    ds_read_b128 a[12:15], v249 offset:60032
    v_cvt_pk_bf16_f32 v239, v239, v245
    v_mfma_f32_16x16x32_bf16 v[68:71], a[80:83], a[116:119], v[68:71]
    s_barrier
    ds_read_b128 a[16:19], v248 offset:1024
    v_mul_f32 v240, v160, v56
    v_mfma_f32_16x16x32_bf16 v[72:75], a[28:31], a[100:103], 1.0
    s_waitcnt lgkmcnt(7)
    ds_read_b128 a[20:23], v249 offset:60240
    v_mul_f32 v244, v164, v60
    v_mfma_f32_16x16x32_bf16 v[212:215], a[32:35], v[236:239], v[212:215]
    s_add_u32 m0, s37, 39040
    ds_read_b128 a[24:27], v248 offset:5248
    buffer_load_dwordx4 v255, s[24:27], s7 offen lds
    v_mfma_f32_16x16x32_bf16 v[76:79], a[36:39], a[100:103], 1.0
    s_waitcnt lgkmcnt(8)
    ds_read_b64 a[84:85], v250 offset:59904
    v_cvt_pk_bf16_f32 v240, v240, v244
    v_mfma_f32_16x16x32_bf16 v[220:223], a[40:43], v[236:239], v[220:223]
    s_waitcnt lgkmcnt(8)
    ds_read_b128 a[28:31], v248 offset:9472
    v_mul_f32 v241, v161, v57
    v_mfma_f32_16x16x32_bf16 v[72:75], a[44:47], a[104:107], v[72:75]
    s_waitcnt lgkmcnt(7)
    v_mul_f32 v245, v165, v61
    v_cvt_pk_bf16_f32 v241, v241, v245
    v_mfma_f32_16x16x32_bf16 v[228:231], a[0:3], v[236:239], v[228:231]
    s_add_u32 m0, s37, 43264
    ds_read_b128 a[32:35], v249 offset:0
    buffer_load_dwordx4 v255, s[24:27], s79 offen lds
    v_mfma_f32_16x16x32_bf16 v[76:79], a[4:7], a[104:107], v[76:79]
    s_waitcnt lgkmcnt(7)
    ds_read_b128 a[36:39], v248 offset:1280
    v_mul_f32 v242, v162, v58
    v_mfma_f32_16x16x32_bf16 v[232:235], a[8:11], v[236:239], v[232:235]
    s_waitcnt lgkmcnt(7)
    ds_read_b128 a[40:43], v249 offset:208
    v_mul_f32 v244, v166, v62
    v_mfma_f32_16x16x32_bf16 v[72:75], a[12:15], a[108:111], v[72:75]
    s_waitcnt lgkmcnt(6)
    ds_read_b128 a[44:47], v248 offset:1536
    v_cvt_pk_bf16_f32 v242, v242, v244
    v_mfma_f32_16x16x32_bf16 v[208:211], a[16:19], v[236:239], v[208:211]
    s_add_u32 m0, s38, 110592
    ds_read_b128 a[0:3], v249 offset:64
    buffer_load_dwordx4 v252, s[12:15], m0 offen lds
    v_mfma_f32_16x16x32_bf16 v[76:79], a[20:23], a[108:111], v[76:79]
    s_waitcnt lgkmcnt(7)
    ds_read_b128 a[4:7], v248 offset:5504
    v_mul_f32 v243, v163, v59
    v_mfma_f32_16x16x32_bf16 v[216:219], a[24:27], v[236:239], v[216:219]
    s_waitcnt lgkmcnt(6)
    ds_read_b128 a[8:11], v249 offset:272
    v_mul_f32 v245, v167, v63
    v_mfma_f32_16x16x32_bf16 v[72:75], a[84:87], a[112:115], v[72:75]
    s_add_u32 s39, s38, 252928
    ds_read_b128 a[12:15], v248 offset:5760
    v_cvt_pk_bf16_f32 v243, v243, v245
    v_mfma_f32_16x16x32_bf16 v[224:227], a[28:31], v[236:239], v[224:227]
    s_add_u32 m0, s38, 133120
    ds_read_b128 a[16:19], v249 offset:128
    buffer_load_dwordx4 v252, s[24:27], s39 offen lds
    v_mfma_f32_16x16x32_bf16 v[76:79], a[84:87], a[116:119], v[76:79]
    s_waitcnt lgkmcnt(8)
    ds_read_b128 a[20:23], v248 offset:9728
    v_mul_f32 v236, v168, v64
    v_mfma_f32_16x16x32_bf16 v[80:83], a[32:35], a[100:103], 1.0
    s_waitcnt lgkmcnt(6)
    ds_read_b128 a[24:27], v249 offset:336
    v_mul_f32 v244, v172, v68
    v_mfma_f32_16x16x32_bf16 v[212:215], a[36:39], v[240:243], v[212:215]
    s_add_u32 s39, s38, 257024
    ds_read_b128 a[28:31], v248 offset:9984
    v_cvt_pk_bf16_f32 v236, v236, v244
    v_mfma_f32_16x16x32_bf16 v[84:87], a[40:43], a[100:103], 1.0
    s_add_u32 m0, s38, 137216
    ds_read_b64 a[88:89], v250 offset:0
    buffer_load_dwordx4 v252, s[24:27], s39 offen lds
    v_mfma_f32_16x16x32_bf16 v[208:211], a[44:47], v[240:243], v[208:211]
    s_waitcnt lgkmcnt(8)
    ds_read_b128 a[32:35], v254 offset:16832
    v_mul_f32 v237, v169, v65
    v_mfma_f32_16x16x32_bf16 v[80:83], a[0:3], a[104:107], v[80:83]
    s_waitcnt lgkmcnt(6)
    v_mul_f32 v245, v173, v69
    v_cvt_pk_bf16_f32 v237, v237, v245
    v_mfma_f32_16x16x32_bf16 v[220:223], a[4:7], v[240:243], v[220:223]
    s_mov_b32 s7, 173056
    ds_read_b128 a[36:39], v249 offset:6656
    v_mul_f32 v238, v170, v66
    v_mfma_f32_16x16x32_bf16 v[84:87], a[8:11], a[104:107], v[84:87]
    s_add_u32 m0, s37, 47488
    ds_read_b128 a[40:43], v248 offset:1792
    buffer_load_dwordx4 v251, s[24:27], s7 offen lds
    v_mfma_f32_16x16x32_bf16 v[216:219], a[12:15], v[240:243], v[216:219]
    s_waitcnt lgkmcnt(7)
    ds_read_b128 a[44:47], v249 offset:6864
    v_mul_f32 v244, v174, v70
    v_mfma_f32_16x16x32_bf16 v[80:83], a[16:19], a[108:111], v[80:83]
    s_waitcnt lgkmcnt(7)
    ds_read_b128 a[0:3], v248 offset:6016
    v_cvt_pk_bf16_f32 v238, v238, v244
    v_mfma_f32_16x16x32_bf16 v[228:231], a[20:23], v[240:243], v[228:231]
    s_waitcnt lgkmcnt(6)
    ds_read_b128 a[4:7], v249 offset:6720
    v_mul_f32 v239, v171, v67
    v_mfma_f32_16x16x32_bf16 v[84:87], a[24:27], a[108:111], v[84:87]
    s_add_u32 m0, s38, 114688
    ds_read_b128 a[8:11], v248 offset:10240
    buffer_load_dwordx4 v252, s[12:15], m0 offen lds
    v_mfma_f32_16x16x32_bf16 v[224:227], a[28:31], v[240:243], v[224:227]
    s_waitcnt lgkmcnt(7)
    ds_read_b128 a[12:15], v249 offset:6928
    v_mul_f32 v245, v175, v71
    v_mfma_f32_16x16x32_bf16 v[80:83], a[88:91], a[112:115], v[80:83]
    s_waitcnt lgkmcnt(7)
    ds_read_b128 a[16:19], v254 offset:16896
    v_cvt_pk_bf16_f32 v239, v239, v245
    v_mfma_f32_16x16x32_bf16 v[232:235], a[32:35], v[240:243], v[232:235]
    s_waitcnt vmcnt(16) lgkmcnt(7)
    ds_read_b128 a[20:23], v249 offset:6784
    v_mul_f32 v240, v176, v72
    v_mfma_f32_16x16x32_bf16 v[84:87], a[88:91], a[116:119], v[84:87]
    s_barrier
    ds_read_b128 a[24:27], v248 offset:13696
    v_mul_f32 v244, v180, v76
    v_mfma_f32_16x16x32_bf16 v[88:91], a[36:39], a[100:103], 1.0
    s_waitcnt lgkmcnt(6)
    ds_read_b128 a[28:31], v249 offset:6992
    v_cvt_pk_bf16_f32 v240, v240, v244
    v_mfma_f32_16x16x32_bf16 v[212:215], a[40:43], v[236:239], v[212:215]
    s_mov_b32 s78, 199680
    ds_read_b128 a[32:35], v248 offset:17920
    v_mul_f32 v241, v177, v73
    v_mfma_f32_16x16x32_bf16 v[92:95], a[44:47], a[100:103], 1.0
    s_add_u32 m0, s37, 51712
    ds_read_b64 a[92:93], v250 offset:6656
    buffer_load_dwordx4 v251, s[24:27], s78 offen lds
    v_mfma_f32_16x16x32_bf16 v[220:223], a[0:3], v[236:239], v[220:223]
    s_waitcnt lgkmcnt(8)
    ds_read_b128 a[36:39], v248 offset:22144
    v_mul_f32 v245, v181, v77
    v_mfma_f32_16x16x32_bf16 v[88:91], a[4:7], a[104:107], v[88:91]
    s_waitcnt lgkmcnt(6)
    v_cvt_pk_bf16_f32 v241, v241, v245
    v_mul_f32 v242, v178, v74
    v_mfma_f32_16x16x32_bf16 v[228:231], a[8:11], v[236:239], v[228:231]
    s_mov_b32 s79, 226304
    ds_read_b128 a[40:43], v249 offset:13312
    v_mul_f32 v244, v182, v78
    v_mfma_f32_16x16x32_bf16 v[92:95], a[12:15], a[104:107], v[92:95]
    s_add_u32 m0, s37, 55936
    ds_read_b128 a[44:47], v248 offset:13952
    buffer_load_dwordx4 v251, s[24:27], s79 offen lds
    v_mfma_f32_16x16x32_bf16 v[232:235], a[16:19], v[236:239], v[232:235]
    s_waitcnt lgkmcnt(7)
    ds_read_b128 a[0:3], v249 offset:13520
    v_cvt_pk_bf16_f32 v242, v242, v244
    v_mfma_f32_16x16x32_bf16 v[88:91], a[20:23], a[108:111], v[88:91]
    s_waitcnt lgkmcnt(7)
    ds_read_b128 a[4:7], v248 offset:14208
    v_mul_f32 v243, v179, v75
    v_mfma_f32_16x16x32_bf16 v[208:211], a[24:27], v[236:239], v[208:211]
    s_waitcnt lgkmcnt(6)
    ds_read_b128 a[8:11], v249 offset:13376
    v_mul_f32 v245, v183, v79
    v_mfma_f32_16x16x32_bf16 v[92:95], a[28:31], a[108:111], v[92:95]
    s_add_u32 m0, s38, 118784
    ds_read_b128 a[12:15], v248 offset:18176
    buffer_load_dwordx4 v252, s[12:15], m0 offen lds
    v_mfma_f32_16x16x32_bf16 v[216:219], a[32:35], v[236:239], v[216:219]
    s_waitcnt lgkmcnt(7)
    ds_read_b128 a[16:19], v249 offset:13584
    v_cvt_pk_bf16_f32 v243, v243, v245
    v_mfma_f32_16x16x32_bf16 v[88:91], a[92:95], a[112:115], v[88:91]
    s_waitcnt lgkmcnt(7)
    ds_read_b128 a[20:23], v248 offset:18432
    v_mfma_f32_16x16x32_bf16 v[224:227], a[36:39], v[236:239], v[224:227]
    s_waitcnt lgkmcnt(7)
    ds_read_b128 a[24:27], v249 offset:13440
    v_mul_f32 v236, v184, v80
    v_mfma_f32_16x16x32_bf16 v[92:95], a[92:95], a[116:119], v[92:95]
    s_add_u32 m0, s38, 122880
    ds_read_b128 a[28:31], v248 offset:22400
    buffer_load_dwordx4 v252, s[12:15], m0 offen lds
    v_mfma_f32_16x16x32_bf16 v[96:99], a[40:43], a[100:103], 1.0
    s_waitcnt lgkmcnt(8)
    ds_read_b128 a[32:35], v249 offset:13648
    v_mul_f32 v244, v188, v84
    v_mfma_f32_16x16x32_bf16 v[212:215], a[44:47], v[240:243], v[212:215]
    s_waitcnt lgkmcnt(8)
    ds_read_b128 a[36:39], v248 offset:22656
    v_cvt_pk_bf16_f32 v236, v236, v244
    v_mfma_f32_16x16x32_bf16 v[100:103], a[0:3], a[100:103], 1.0
    s_waitcnt lgkmcnt(7)
    ds_read_b64 a[96:97], v250 offset:13312
    v_mul_f32 v237, v185, v81
    v_mfma_f32_16x16x32_bf16 v[208:211], a[4:7], v[240:243], v[208:211]
    s_add_u32 m0, s37, 60032
    ds_read_b128 a[40:43], v254 offset:16960
    buffer_load_dwordx4 v251, s[24:27], s7 offen offset:128 lds
    v_mfma_f32_16x16x32_bf16 v[96:99], a[8:11], a[104:107], v[96:99]
    s_waitcnt lgkmcnt(8)
    v_mul_f32 v245, v189, v85
    v_cvt_pk_bf16_f32 v237, v237, v245
    v_mfma_f32_16x16x32_bf16 v[220:223], a[12:15], v[240:243], v[220:223]
    s_waitcnt lgkmcnt(7)
    ds_read_b128 a[44:47], v248 offset:14464
    v_mul_f32 v238, v186, v82
    v_mfma_f32_16x16x32_bf16 v[100:103], a[16:19], a[104:107], v[100:103]
    s_waitcnt lgkmcnt(6)
    ds_read_b128 a[0:3], v248 offset:18688
    v_mul_f32 v244, v190, v86
    v_mfma_f32_16x16x32_bf16 v[216:219], a[20:23], v[240:243], v[216:219]
    s_add_u32 m0, s38, 126976
    ds_read_b128 a[4:7], v248 offset:22912
    buffer_load_dwordx4 v252, s[12:15], m0 offen lds
    v_mfma_f32_16x16x32_bf16 v[96:99], a[24:27], a[108:111], v[96:99]
    s_waitcnt vmcnt(11) lgkmcnt(6)
    ds_read_b128 a[8:11], v254 offset:17024
    v_cvt_pk_bf16_f32 v238, v238, v244
    v_mfma_f32_16x16x32_bf16 v[228:231], a[28:31], v[240:243], v[228:231]
    s_barrier
    ds_read_b128 a[12:15], v248 offset:26368
    v_mul_f32 v239, v187, v83
    v_mfma_f32_16x16x32_bf16 v[100:103], a[32:35], a[108:111], v[100:103]
    s_waitcnt lgkmcnt(6)
    ds_read_b128 a[16:19], v248 offset:30592
    v_mul_f32 v245, v191, v87
    v_mfma_f32_16x16x32_bf16 v[224:227], a[36:39], v[240:243], v[224:227]
    s_add_u32 m0, s37, 896
    ds_read_b128 a[20:23], v248 offset:34816
    buffer_load_dwordx4 v251, s[24:27], s78 offen offset:128 lds
    v_mfma_f32_16x16x32_bf16 v[96:99], a[96:99], a[112:115], v[96:99]
    s_waitcnt lgkmcnt(7)
    ds_read_b128 a[24:27], v248 offset:26624
    v_cvt_pk_bf16_f32 v239, v239, v245
    v_mfma_f32_16x16x32_bf16 v[232:235], a[40:43], v[240:243], v[232:235]
    ds_read_b128 a[28:31], v248 offset:26880
    v_mul_f32 v240, v192, v88
    v_mfma_f32_16x16x32_bf16 v[100:103], a[96:99], a[116:119], v[100:103]
    s_waitcnt lgkmcnt(7)
    ds_read_b128 a[32:35], v248 offset:30848
    v_mul_f32 v244, v196, v92
    v_mfma_f32_16x16x32_bf16 v[212:215], a[44:47], v[236:239], v[212:215]
    s_add_u32 m0, s37, 5120
    ds_read_b128 a[36:39], v248 offset:31104
    buffer_load_dwordx4 v251, s[24:27], s79 offen offset:128 lds
    v_mfma_f32_16x16x32_bf16 v[220:223], a[0:3], v[236:239], v[220:223]
    s_waitcnt lgkmcnt(8)
    ds_read_b128 a[40:43], v248 offset:35072
    v_cvt_pk_bf16_f32 v240, v240, v244
    v_mul_f32 v241, v193, v89
    v_mfma_f32_16x16x32_bf16 v[228:231], a[4:7], v[236:239], v[228:231]
    s_waitcnt lgkmcnt(6)
    ds_read_b128 a[44:47], v248 offset:35328
    v_mul_f32 v245, v197, v93
    v_cvt_pk_bf16_f32 v241, v241, v245
    v_mfma_f32_16x16x32_bf16 v[232:235], a[8:11], v[236:239], v[232:235]
    s_add_u32 s39, s38, 131072
    ds_read_b128 a[0:3], v254 offset:17088
    v_mul_f32 v242, v194, v90
    v_mul_f32 v244, v198, v94
    v_mfma_f32_16x16x32_bf16 v[208:211], a[12:15], v[236:239], v[208:211]
    s_mov_b32 m0, s49
    ds_read_b128 a[4:7], v248 offset:27136
    buffer_load_dwordx4 v252, s[12:15], s39 offen lds
    v_cvt_pk_bf16_f32 v242, v242, v244
    v_mul_f32 v243, v195, v91
    v_mfma_f32_16x16x32_bf16 v[216:219], a[16:19], v[236:239], v[216:219]
    s_waitcnt lgkmcnt(8)
    ds_read_b128 a[8:11], v248 offset:39040
    v_mul_f32 v245, v199, v95
    v_cvt_pk_bf16_f32 v243, v243, v245
    v_mfma_f32_16x16x32_bf16 v[224:227], a[20:23], v[236:239], v[224:227]
    s_waitcnt lgkmcnt(8)
    ds_read_b128 a[12:15], v248 offset:31360
    v_mul_f32 v236, v200, v96
    v_mfma_f32_16x16x32_bf16 v[212:215], a[24:27], v[240:243], v[212:215]
    s_waitcnt lgkmcnt(7)
    ds_read_b128 a[16:19], v248 offset:39552
    v_mul_f32 v244, v204, v100
    v_mfma_f32_16x16x32_bf16 v[208:211], a[28:31], v[240:243], v[208:211]
    s_add_u32 m0, s38, 68608
    ds_read_b128 a[20:23], v248 offset:35584
    buffer_load_dwordx4 v252, s[28:31], m0 offen lds
    v_cvt_pk_bf16_f32 v236, v236, v244
    v_mul_f32 v237, v201, v97
    v_mfma_f32_16x16x32_bf16 v[220:223], a[32:35], v[240:243], v[220:223]
    s_waitcnt lgkmcnt(8)
    ds_read_b128 a[24:27], v248 offset:43264
    v_mul_f32 v245, v205, v101
    v_cvt_pk_bf16_f32 v237, v237, v245
    v_mfma_f32_16x16x32_bf16 v[216:219], a[36:39], v[240:243], v[216:219]
    s_waitcnt lgkmcnt(8)
    ds_read_b128 a[28:31], v254 offset:17152
    v_mul_f32 v238, v202, v98
    v_mul_f32 v244, v206, v102
    v_mfma_f32_16x16x32_bf16 v[228:231], a[40:43], v[240:243], v[228:231]
    s_waitcnt lgkmcnt(7)
    ds_read_b128 a[32:35], v249 offset:19968
    v_cvt_pk_bf16_f32 v238, v238, v244
    v_mul_f32 v239, v203, v99
    v_mfma_f32_16x16x32_bf16 v[224:227], a[44:47], v[240:243], v[224:227]
    s_add_u32 m0, s38, 72704
    ds_read_b128 a[36:39], v249 offset:20176
    buffer_load_dwordx4 v252, s[28:31], m0 offen lds
    v_mul_f32 v245, v207, v103
    v_cvt_pk_bf16_f32 v239, v239, v245
    v_mfma_f32_16x16x32_bf16 v[232:235], a[0:3], v[240:243], v[232:235]
    s_waitcnt lgkmcnt(8)
    ds_read_b128 a[40:43], v249 offset:26624
    v_mfma_f32_16x16x32_bf16 v[212:215], a[4:7], v[236:239], v[212:215]
    s_waitcnt lgkmcnt(8)
    ds_read_b128 a[44:47], v249 offset:26832
    v_mfma_f32_16x16x32_bf16 v[208:211], a[8:11], v[236:239], v[208:211]
    s_waitcnt lgkmcnt(7)
    ds_read_b128 a[0:3], v249 offset:20032
    v_mfma_f32_16x16x32_bf16 v[220:223], a[12:15], v[236:239], v[220:223]
    s_add_u32 m0, s37, 9216
    ds_read_b128 a[4:7], v249 offset:20240
    buffer_load_dwordx4 v251, s[24:27], s7 offen offset:256 lds
    v_mfma_f32_16x16x32_bf16 v[216:219], a[16:19], v[236:239], v[216:219]
    s_waitcnt lgkmcnt(8)
    ds_read_b128 a[8:11], v249 offset:26688
    v_cvt_pk_bf16_f32 v208, v208, v212
    v_cvt_pk_bf16_f32 v209, v209, v213
    v_cvt_pk_bf16_f32 v210, v210, v214
    v_mfma_f32_16x16x32_bf16 v[228:231], a[20:23], v[236:239], v[228:231]
    s_waitcnt lgkmcnt(8)
    ds_read_b128 a[12:15], v249 offset:26896
    v_cvt_pk_bf16_f32 v211, v211, v215
    v_accvgpr_write_b32 a100, v208
    v_accvgpr_write_b32 a101, v209
    v_mfma_f32_16x16x32_bf16 v[224:227], a[24:27], v[236:239], v[224:227]
    s_waitcnt lgkmcnt(8)
    ds_read_b128 a[16:19], v249 offset:20096
    v_accvgpr_write_b32 a102, v210
    v_accvgpr_write_b32 a103, v211
    v_mfma_f32_16x16x32_bf16 v[232:235], a[28:31], v[236:239], v[232:235]
    s_waitcnt lgkmcnt(8)
    ds_read_b128 a[20:23], v249 offset:20304
    v_cvt_pk_bf16_f32 v216, v216, v220
    v_cvt_pk_bf16_f32 v217, v217, v221
    v_mfma_f32_16x16x32_bf16 v[0:3], a[32:35], a[100:103], v[0:3]
    s_waitcnt lgkmcnt(8)
    ds_read_b128 a[24:27], v249 offset:26752
    v_cvt_pk_bf16_f32 v218, v218, v222
    v_cvt_pk_bf16_f32 v219, v219, v223
    v_mfma_f32_16x16x32_bf16 v[4:7], a[36:39], a[100:103], v[4:7]
    s_waitcnt lgkmcnt(8)
    ds_read_b128 a[28:31], v249 offset:26960
    v_accvgpr_write_b32 a104, v216
    v_accvgpr_write_b32 a105, v217
    v_mfma_f32_16x16x32_bf16 v[8:11], a[40:43], a[100:103], v[8:11]
    s_waitcnt lgkmcnt(8)
    ds_read_b64 a[48:49], v250 offset:19968
    v_accvgpr_write_b32 a106, v218
    v_accvgpr_write_b32 a107, v219
    v_mfma_f32_16x16x32_bf16 v[12:15], a[44:47], a[100:103], v[12:15]
    s_waitcnt lgkmcnt(8)
    v_cvt_pk_bf16_f32 v224, v224, v228
    v_cvt_pk_bf16_f32 v225, v225, v229
    v_mfma_f32_16x16x32_bf16 v[0:3], a[0:3], a[104:107], v[0:3]
    s_waitcnt vmcnt(10) lgkmcnt(5)
    ds_read_b64 a[52:53], v250 offset:26624
    v_cvt_pk_bf16_f32 v226, v226, v230
    v_cvt_pk_bf16_f32 v227, v227, v231
    v_mfma_f32_16x16x32_bf16 v[4:7], a[4:7], a[104:107], v[4:7]
    s_barrier
    v_accvgpr_write_b32 a108, v224
    v_accvgpr_write_b32 a109, v225
    v_mfma_f32_16x16x32_bf16 v[8:11], a[8:11], a[104:107], v[8:11]
    s_add_u32 m0, s37, 13440
    ds_read_b128 a[32:35], v249 offset:33280
    buffer_load_dwordx4 v251, s[24:27], s78 offen offset:256 lds
    v_accvgpr_write_b32 a110, v226
    v_accvgpr_write_b32 a111, v227
    v_mfma_f32_16x16x32_bf16 v[12:15], a[12:15], a[104:107], v[12:15]
    s_waitcnt lgkmcnt(6)
    ds_read_b128 a[36:39], v249 offset:33488
    v_cvt_pk_bf16_f32 v232, v232, v233
    v_mfma_f32_16x16x32_bf16 v[0:3], a[16:19], a[108:111], v[0:3]
    s_waitcnt lgkmcnt(6)
    ds_read_b128 a[40:43], v249 offset:33344
    v_cvt_pk_bf16_f32 v233, v234, v235
    v_mfma_f32_16x16x32_bf16 v[4:7], a[20:23], a[108:111], v[4:7]
    s_waitcnt lgkmcnt(5)
    ds_read_b128 a[44:47], v249 offset:33552
    v_cndmask_b32 v234, 0, v232, s[40:41]
    v_cndmask_b32 v235, 0, v233, s[40:41]
    v_mfma_f32_16x16x32_bf16 v[8:11], a[24:27], a[108:111], v[8:11]
    s_add_u32 m0, s37, 17664
    ds_read_b128 a[0:3], v249 offset:33408
    buffer_load_dwordx4 v251, s[24:27], s79 offen offset:256 lds
    v_accvgpr_write_b32 a120, v234
    v_accvgpr_write_b32 a121, v235
    v_mfma_f32_16x16x32_bf16 v[12:15], a[28:31], a[108:111], v[12:15]
    s_waitcnt lgkmcnt(6)
    ds_read_b128 a[4:7], v249 offset:33616
    v_cndmask_b32 v232, v232, 0, s[40:41]
    v_cndmask_b32 v233, v233, 0, s[40:41]
    v_accvgpr_write_b32 a124, v232
    v_accvgpr_write_b32 a125, v233
    v_mfma_f32_16x16x32_bf16 v[0:3], a[48:51], a[120:123], v[0:3]
    ds_read_b64 a[56:57], v250 offset:33280
    v_mfma_f32_16x16x32_bf16 v[4:7], a[48:51], a[124:127], v[4:7]
    s_waitcnt lgkmcnt(7)
    v_mfma_f32_16x16x32_bf16 v[8:11], a[52:55], a[120:123], v[8:11]
    s_add_u32 m0, s38, 76800
    ds_read_b128 a[8:11], v249 offset:39936
    buffer_load_dwordx4 v252, s[28:31], m0 offen lds
    v_mfma_f32_16x16x32_bf16 v[12:15], a[52:55], a[124:127], v[12:15]
    s_waitcnt lgkmcnt(7)
    ds_read_b128 a[12:15], v248 offset:39296
    v_mul_f32 v236, v104, v0
    v_mfma_f32_16x16x32_bf16 v[16:19], a[32:35], a[100:103], v[16:19]
    s_waitcnt lgkmcnt(7)
    ds_read_b128 a[16:19], v249 offset:40144
    v_mul_f32 v244, v108, v4
    v_mfma_f32_16x16x32_bf16 v[20:23], a[36:39], a[100:103], v[20:23]
    s_waitcnt lgkmcnt(6)
    ds_read_b128 a[20:23], v248 offset:39808
    v_cvt_pk_bf16_f32 v236, v236, v244
    v_mfma_f32_16x16x32_bf16 v[16:19], a[40:43], a[104:107], v[16:19]
    s_add_u32 m0, s38, 80896
    ds_read_b128 a[24:27], v249 offset:40000
    buffer_load_dwordx4 v252, s[28:31], m0 offen lds
    v_mfma_f32_16x16x32_bf16 v[20:23], a[44:47], a[104:107], v[20:23]
    s_waitcnt lgkmcnt(7)
    ds_read_b128 a[28:31], v248 offset:43520
    v_mul_f32 v237, v105, v1
    v_mfma_f32_16x16x32_bf16 v[16:19], a[0:3], a[108:111], v[16:19]
    s_waitcnt lgkmcnt(7)
    ds_read_b128 a[32:35], v249 offset:40208
    v_mul_f32 v245, v109, v5
    v_cvt_pk_bf16_f32 v237, v237, v245
    v_mfma_f32_16x16x32_bf16 v[20:23], a[4:7], a[108:111], v[20:23]
    s_waitcnt lgkmcnt(7)
    ds_read_b128 a[36:39], v254 offset:0
    v_mul_f32 v238, v106, v2
    v_mul_f32 v244, v110, v6
    v_mfma_f32_16x16x32_bf16 v[16:19], a[56:59], a[120:123], v[16:19]
    s_add_u32 m0, s37, 21760
    ds_read_b128 a[40:43], v249 offset:40064
    buffer_load_dwordx4 v251, s[24:27], s7 offen offset:384 lds
    v_cvt_pk_bf16_f32 v238, v238, v244
    v_mul_f32 v239, v107, v3
    v_mfma_f32_16x16x32_bf16 v[20:23], a[56:59], a[124:127], v[20:23]
    s_waitcnt lgkmcnt(8)
    ds_read_b128 a[44:47], v248 offset:47488
    v_mul_f32 v245, v111, v7
    v_cvt_pk_bf16_f32 v239, v239, v245
    v_mfma_f32_16x16x32_bf16 v[24:27], a[8:11], a[100:103], v[24:27]
    s_waitcnt lgkmcnt(8)
    ds_read_b128 a[0:3], v249 offset:40272
    v_mul_f32 v240, v112, v8
    v_mfma_f32_16x16x32_bf16 v[212:215], a[12:15], v[236:239], 0
    s_waitcnt lgkmcnt(7)
    ds_read_b128 a[4:7], v248 offset:51712
    v_mul_f32 v244, v116, v12
    v_mfma_f32_16x16x32_bf16 v[28:31], a[16:19], a[100:103], v[28:31]
    s_add_u32 m0, s37, 25984
    ds_read_b64 a[60:61], v250 offset:39936
    buffer_load_dwordx4 v251, s[24:27], s78 offen offset:384 lds
    v_mfma_f32_16x16x32_bf16 v[220:223], a[20:23], v[236:239], 0
    s_waitcnt lgkmcnt(8)
    ds_read_b128 a[8:11], v248 offset:55936
    v_cvt_pk_bf16_f32 v240, v240, v244
    v_mfma_f32_16x16x32_bf16 v[24:27], a[24:27], a[104:107], v[24:27]
    s_waitcnt vmcnt(10) lgkmcnt(6)
    v_mul_f32 v241, v113, v9
    v_mul_f32 v245, v117, v13
    v_mfma_f32_16x16x32_bf16 v[228:231], a[28:31], v[236:239], 0
    s_barrier
    ds_read_b128 a[12:15], v249 offset:46592
    v_cvt_pk_bf16_f32 v241, v241, v245
    v_mfma_f32_16x16x32_bf16 v[28:31], a[32:35], a[104:107], v[28:31]
    s_add_u32 m0, s38, 84992
    ds_read_b128 a[16:19], v248 offset:47744
    buffer_load_dwordx4 v252, s[28:31], m0 offen lds
    v_mfma_f32_16x16x32_bf16 v[232:235], a[36:39], v[236:239], 0
    s_waitcnt lgkmcnt(7)
    ds_read_b128 a[20:23], v249 offset:46800
    v_mul_f32 v242, v114, v10
    v_mfma_f32_16x16x32_bf16 v[24:27], a[40:43], a[108:111], v[24:27]
    s_waitcnt lgkmcnt(7)
    ds_read_b128 a[24:27], v248 offset:48000
    v_mul_f32 v244, v118, v14
    v_mfma_f32_16x16x32_bf16 v[208:211], a[44:47], v[236:239], 0
    s_waitcnt lgkmcnt(6)
    ds_read_b128 a[28:31], v249 offset:46656
    v_cvt_pk_bf16_f32 v242, v242, v244
    v_mfma_f32_16x16x32_bf16 v[28:31], a[0:3], a[108:111], v[28:31]
    s_add_u32 m0, s37, 30208
    ds_read_b128 a[32:35], v248 offset:51968
    buffer_load_dwordx4 v251, s[24:27], s79 offen offset:384 lds
    v_mfma_f32_16x16x32_bf16 v[216:219], a[4:7], v[236:239], 0
    s_waitcnt lgkmcnt(7)
    ds_read_b128 a[36:39], v249 offset:46864
    v_mul_f32 v243, v115, v11
    v_mfma_f32_16x16x32_bf16 v[24:27], a[60:63], a[120:123], v[24:27]
    s_waitcnt lgkmcnt(7)
    ds_read_b128 a[40:43], v248 offset:52224
    v_mul_f32 v245, v119, v15
    v_mfma_f32_16x16x32_bf16 v[224:227], a[8:11], v[236:239], 0
    s_waitcnt lgkmcnt(7)
    ds_read_b128 a[44:47], v249 offset:46720
    v_cvt_pk_bf16_f32 v243, v243, v245
    v_mfma_f32_16x16x32_bf16 v[28:31], a[60:63], a[124:127], v[28:31]
    s_add_u32 m0, s38, 89088
    ds_read_b128 a[0:3], v248 offset:56192
    buffer_load_dwordx4 v252, s[28:31], m0 offen lds
    v_mfma_f32_16x16x32_bf16 v[32:35], a[12:15], a[100:103], v[32:35]
    s_waitcnt lgkmcnt(8)
    ds_read_b128 a[4:7], v249 offset:46928
    v_mul_f32 v236, v120, v16
    v_mfma_f32_16x16x32_bf16 v[212:215], a[16:19], v[240:243], v[212:215]
    s_waitcnt lgkmcnt(8)
    ds_read_b128 a[8:11], v248 offset:56448
    v_mul_f32 v244, v124, v20
    v_mfma_f32_16x16x32_bf16 v[36:39], a[20:23], a[100:103], v[36:39]
    s_waitcnt lgkmcnt(7)
    ds_read_b64 a[64:65], v250 offset:46592
    v_cvt_pk_bf16_f32 v236, v236, v244
    v_mfma_f32_16x16x32_bf16 v[208:211], a[24:27], v[240:243], v[208:211]
    s_add_u32 m0, s38, 93184
    ds_read_b128 a[12:15], v254 offset:64
    buffer_load_dwordx4 v252, s[28:31], m0 offen lds
    v_mfma_f32_16x16x32_bf16 v[32:35], a[28:31], a[104:107], v[32:35]
    s_waitcnt lgkmcnt(8)
    v_mul_f32 v237, v121, v17
    v_mul_f32 v245, v125, v21
    v_mfma_f32_16x16x32_bf16 v[220:223], a[32:35], v[240:243], v[220:223]
    s_waitcnt lgkmcnt(7)
    ds_read_b128 a[16:19], v249 offset:53248
    v_cvt_pk_bf16_f32 v237, v237, v245
    v_mfma_f32_16x16x32_bf16 v[36:39], a[36:39], a[104:107], v[36:39]
    s_waitcnt lgkmcnt(6)
    ds_read_b128 a[20:23], v248 offset:48256
    v_mul_f32 v238, v122, v18
    v_mfma_f32_16x16x32_bf16 v[216:219], a[40:43], v[240:243], v[216:219]
    s_add_u32 m0, s38, 97280
    ds_read_b128 a[24:27], v249 offset:53456
    buffer_load_dwordx4 v252, s[28:31], m0 offen lds
    v_mfma_f32_16x16x32_bf16 v[32:35], a[44:47], a[108:111], v[32:35]
    s_waitcnt lgkmcnt(7)
    ds_read_b128 a[28:31], v248 offset:52480
    v_mul_f32 v244, v126, v22
    v_mfma_f32_16x16x32_bf16 v[228:231], a[0:3], v[240:243], v[228:231]
    s_waitcnt lgkmcnt(7)
    ds_read_b128 a[32:35], v249 offset:53312
    v_cvt_pk_bf16_f32 v238, v238, v244
    v_mfma_f32_16x16x32_bf16 v[36:39], a[4:7], a[108:111], v[36:39]
    s_waitcnt lgkmcnt(6)
    ds_read_b128 a[36:39], v248 offset:56704
    v_mul_f32 v239, v123, v19
    v_mfma_f32_16x16x32_bf16 v[224:227], a[8:11], v[240:243], v[224:227]
    s_add_u32 m0, s37, 34304
    ds_read_b128 a[40:43], v249 offset:53520
    buffer_load_dwordx4 v251, s[24:27], s7 offen offset:512 lds
    v_mfma_f32_16x16x32_bf16 v[32:35], a[64:67], a[120:123], v[32:35]
    s_waitcnt lgkmcnt(7)
    ds_read_b128 a[44:47], v254 offset:128
    v_mul_f32 v245, v127, v23
    v_mfma_f32_16x16x32_bf16 v[232:235], a[12:15], v[240:243], v[232:235]
    ds_read_b128 a[0:3], v249 offset:53376
    v_cvt_pk_bf16_f32 v239, v239, v245
    v_mfma_f32_16x16x32_bf16 v[36:39], a[64:67], a[124:127], v[36:39]
    s_waitcnt lgkmcnt(7)
    ds_read_b128 a[4:7], v248 offset:60160
    v_mul_f32 v240, v128, v24
    v_mfma_f32_16x16x32_bf16 v[40:43], a[16:19], a[100:103], v[40:43]
    s_add_u32 m0, s37, 38528
    ds_read_b128 a[8:11], v249 offset:53584
    buffer_load_dwordx4 v251, s[24:27], s78 offen offset:512 lds
    v_mfma_f32_16x16x32_bf16 v[212:215], a[20:23], v[236:239], v[212:215]
    s_waitcnt lgkmcnt(8)
    ds_read_b128 a[12:15], v248 offset:1024
    v_mul_f32 v244, v132, v28
    v_mfma_f32_16x16x32_bf16 v[44:47], a[24:27], a[100:103], v[44:47]
    s_waitcnt lgkmcnt(8)
    ds_read_b64 a[68:69], v250 offset:53248
    v_cvt_pk_bf16_f32 v240, v240, v244
    v_mfma_f32_16x16x32_bf16 v[220:223], a[28:31], v[236:239], v[220:223]
    s_waitcnt lgkmcnt(8)
    ds_read_b128 a[16:19], v248 offset:5248
    v_mul_f32 v241, v129, v25
    v_mfma_f32_16x16x32_bf16 v[40:43], a[32:35], a[104:107], v[40:43]
    s_waitcnt vmcnt(11) lgkmcnt(6)
    v_mul_f32 v245, v133, v29
    v_cvt_pk_bf16_f32 v241, v241, v245
    v_mfma_f32_16x16x32_bf16 v[228:231], a[36:39], v[236:239], v[228:231]
    s_barrier
    ds_read_b128 a[20:23], v249 offset:59904
    v_mul_f32 v242, v130, v26
    v_mfma_f32_16x16x32_bf16 v[44:47], a[40:43], a[104:107], v[44:47]
    s_add_u32 m0, s37, 42752
    ds_read_b128 a[24:27], v248 offset:60416
    buffer_load_dwordx4 v251, s[24:27], s79 offen offset:512 lds
    v_mfma_f32_16x16x32_bf16 v[232:235], a[44:47], v[236:239], v[232:235]
    s_waitcnt lgkmcnt(7)
    ds_read_b128 a[28:31], v249 offset:60112
    v_mul_f32 v244, v134, v30
    v_mfma_f32_16x16x32_bf16 v[40:43], a[0:3], a[108:111], v[40:43]
    s_waitcnt lgkmcnt(7)
    ds_read_b128 a[32:35], v248 offset:60672
    v_cvt_pk_bf16_f32 v242, v242, v244
    v_mfma_f32_16x16x32_bf16 v[208:211], a[4:7], v[236:239], v[208:211]
    s_waitcnt lgkmcnt(6)
    ds_read_b128 a[36:39], v249 offset:59968
    v_mul_f32 v243, v131, v27
    v_mfma_f32_16x16x32_bf16 v[44:47], a[8:11], a[108:111], v[44:47]
    s_add_u32 m0, s38, 101376
    ds_read_b128 a[40:43], v248 offset:1280
    buffer_load_dwordx4 v252, s[28:31], m0 offen lds
    v_mfma_f32_16x16x32_bf16 v[216:219], a[12:15], v[236:239], v[216:219]
    s_waitcnt lgkmcnt(7)
    ds_read_b128 a[44:47], v249 offset:60176
    v_mul_f32 v245, v135, v31
    v_mfma_f32_16x16x32_bf16 v[40:43], a[68:71], a[120:123], v[40:43]
    s_waitcnt lgkmcnt(7)
    ds_read_b128 a[0:3], v248 offset:1536
    v_cvt_pk_bf16_f32 v243, v243, v245
    v_mfma_f32_16x16x32_bf16 v[224:227], a[16:19], v[236:239], v[224:227]
    s_waitcnt lgkmcnt(7)
    ds_read_b128 a[4:7], v249 offset:60032
    v_mul_f32 v236, v136, v32
    v_mfma_f32_16x16x32_bf16 v[44:47], a[68:71], a[124:127], v[44:47]
    s_add_u32 m0, s38, 105472
    ds_read_b128 a[8:11], v248 offset:5504
    buffer_load_dwordx4 v252, s[28:31], m0 offen lds
    v_mfma_f32_16x16x32_bf16 v[48:51], a[20:23], a[100:103], v[48:51]
    s_waitcnt lgkmcnt(8)
    ds_read_b128 a[12:15], v249 offset:60240
    v_mul_f32 v244, v140, v36
    v_mfma_f32_16x16x32_bf16 v[212:215], a[24:27], v[240:243], v[212:215]
    s_waitcnt lgkmcnt(8)
    ds_read_b128 a[16:19], v248 offset:5760
    v_cvt_pk_bf16_f32 v236, v236, v244
    v_mfma_f32_16x16x32_bf16 v[52:55], a[28:31], a[100:103], v[52:55]
    s_waitcnt lgkmcnt(7)
    ds_read_b64 a[72:73], v250 offset:59904
    v_mul_f32 v237, v137, v33
    v_mfma_f32_16x16x32_bf16 v[208:211], a[32:35], v[240:243], v[208:211]
    s_add_u32 m0, s37, 46848
    ds_read_b128 a[20:23], v254 offset:192
    buffer_load_dwordx4 v251, s[24:27], s7 offen offset:640 lds
    v_mfma_f32_16x16x32_bf16 v[48:51], a[36:39], a[104:107], v[48:51]
    s_waitcnt lgkmcnt(8)
    v_mul_f32 v245, v141, v37
    v_cvt_pk_bf16_f32 v237, v237, v245
    v_mfma_f32_16x16x32_bf16 v[220:223], a[40:43], v[240:243], v[220:223]
    s_waitcnt lgkmcnt(7)
    ds_read_b128 a[24:27], v249 offset:0
    v_mul_f32 v238, v138, v34
    v_mfma_f32_16x16x32_bf16 v[52:55], a[44:47], a[104:107], v[52:55]
    s_waitcnt lgkmcnt(6)
    ds_read_b128 a[28:31], v248 offset:60928
    v_mul_f32 v244, v142, v38
    v_mfma_f32_16x16x32_bf16 v[216:219], a[0:3], v[240:243], v[216:219]
    s_add_u32 m0, s37, 51072
    ds_read_b128 a[32:35], v249 offset:208
    buffer_load_dwordx4 v251, s[24:27], s78 offen offset:640 lds
    v_mfma_f32_16x16x32_bf16 v[48:51], a[4:7], a[108:111], v[48:51]
    s_waitcnt lgkmcnt(7)
    ds_read_b128 a[36:39], v248 offset:1792
    v_cvt_pk_bf16_f32 v238, v238, v244
    v_mfma_f32_16x16x32_bf16 v[228:231], a[8:11], v[240:243], v[228:231]
    s_waitcnt lgkmcnt(7)
    ds_read_b128 a[40:43], v249 offset:64
    v_mul_f32 v239, v139, v35
    v_mfma_f32_16x16x32_bf16 v[52:55], a[12:15], a[108:111], v[52:55]
    s_waitcnt lgkmcnt(6)
    ds_read_b128 a[44:47], v248 offset:6016
    v_mul_f32 v245, v143, v39
    v_mfma_f32_16x16x32_bf16 v[224:227], a[16:19], v[240:243], v[224:227]
    s_add_u32 m0, s37, 55296
    ds_read_b128 a[0:3], v249 offset:272
    buffer_load_dwordx4 v251, s[24:27], s79 offen offset:640 lds
    v_mfma_f32_16x16x32_bf16 v[48:51], a[72:75], a[120:123], v[48:51]
    s_waitcnt lgkmcnt(7)
    ds_read_b128 a[4:7], v254 offset:256
    v_cvt_pk_bf16_f32 v239, v239, v245
    v_mfma_f32_16x16x32_bf16 v[232:235], a[20:23], v[240:243], v[232:235]
    ds_read_b128 a[8:11], v249 offset:128
    v_mul_f32 v240, v144, v40
    v_mfma_f32_16x16x32_bf16 v[52:55], a[72:75], a[124:127], v[52:55]
    s_waitcnt lgkmcnt(7)
    ds_read_b128 a[12:15], v248 offset:9472
    v_mul_f32 v244, v148, v44
    v_mfma_f32_16x16x32_bf16 v[56:59], a[24:27], a[100:103], v[56:59]
    s_add_u32 m0, s38, 109568
    ds_read_b128 a[16:19], v249 offset:336
    buffer_load_dwordx4 v252, s[28:31], m0 offen lds
    v_mfma_f32_16x16x32_bf16 v[212:215], a[28:31], v[236:239], v[212:215]
    s_waitcnt lgkmcnt(8)
    ds_read_b128 a[20:23], v248 offset:13696
    v_cvt_pk_bf16_f32 v240, v240, v244
    v_mfma_f32_16x16x32_bf16 v[60:63], a[32:35], a[100:103], v[60:63]
    s_waitcnt lgkmcnt(8)
    ds_read_b64 a[76:77], v250 offset:0
    v_mul_f32 v241, v145, v41
    v_mfma_f32_16x16x32_bf16 v[220:223], a[36:39], v[236:239], v[220:223]
    s_waitcnt lgkmcnt(8)
    ds_read_b128 a[24:27], v248 offset:17920
    v_mul_f32 v245, v149, v45
    v_mfma_f32_16x16x32_bf16 v[56:59], a[40:43], a[104:107], v[56:59]
    s_waitcnt vmcnt(12) lgkmcnt(6)
    v_cvt_pk_bf16_f32 v241, v241, v245
    v_mul_f32 v242, v146, v42
    v_mfma_f32_16x16x32_bf16 v[228:231], a[44:47], v[236:239], v[228:231]
    s_barrier
    ds_read_b128 a[28:31], v249 offset:6656
    v_mul_f32 v244, v150, v46
    v_mfma_f32_16x16x32_bf16 v[60:63], a[0:3], a[104:107], v[60:63]
    s_add_u32 m0, s37, 60160
    ds_read_b128 a[32:35], v248 offset:9728
    buffer_load_dwordx4 v255, s[24:27], s7 offen lds
    v_mfma_f32_16x16x32_bf16 v[232:235], a[4:7], v[236:239], v[232:235]
    s_waitcnt lgkmcnt(7)
    ds_read_b128 a[36:39], v249 offset:6864
    v_cvt_pk_bf16_f32 v242, v242, v244
    v_mfma_f32_16x16x32_bf16 v[56:59], a[8:11], a[108:111], v[56:59]
    s_waitcnt lgkmcnt(7)
    ds_read_b128 a[40:43], v248 offset:9984
    v_mul_f32 v243, v147, v43
    v_mfma_f32_16x16x32_bf16 v[208:211], a[12:15], v[236:239], v[208:211]
    s_waitcnt lgkmcnt(6)
    ds_read_b128 a[44:47], v249 offset:6720
    v_mul_f32 v245, v151, v47
    v_mfma_f32_16x16x32_bf16 v[60:63], a[16:19], a[108:111], v[60:63]
    s_add_u32 m0, s37, 1024
    ds_read_b128 a[0:3], v248 offset:13952
    buffer_load_dwordx4 v255, s[24:27], s79 offen lds
    v_mfma_f32_16x16x32_bf16 v[216:219], a[20:23], v[236:239], v[216:219]
    s_waitcnt lgkmcnt(7)
    ds_read_b128 a[4:7], v249 offset:6928
    v_cvt_pk_bf16_f32 v243, v243, v245
    v_mfma_f32_16x16x32_bf16 v[56:59], a[76:79], a[120:123], v[56:59]
    s_waitcnt lgkmcnt(7)
    ds_read_b128 a[8:11], v248 offset:14208
    v_mfma_f32_16x16x32_bf16 v[224:227], a[24:27], v[236:239], v[224:227]
    s_waitcnt lgkmcnt(7)
    ds_read_b128 a[12:15], v249 offset:6784
    v_mul_f32 v236, v152, v48
    v_mfma_f32_16x16x32_bf16 v[60:63], a[76:79], a[124:127], v[60:63]
    s_add_u32 m0, s38, 113664
    ds_read_b128 a[16:19], v248 offset:18176
    buffer_load_dwordx4 v252, s[28:31], m0 offen lds
    v_mfma_f32_16x16x32_bf16 v[64:67], a[28:31], a[100:103], v[64:67]
    s_waitcnt lgkmcnt(8)
    ds_read_b128 a[20:23], v249 offset:6992
    v_mul_f32 v244, v156, v52
    v_mfma_f32_16x16x32_bf16 v[212:215], a[32:35], v[240:243], v[212:215]
    s_waitcnt lgkmcnt(8)
    ds_read_b128 a[24:27], v248 offset:18432
    v_cvt_pk_bf16_f32 v236, v236, v244
    v_mfma_f32_16x16x32_bf16 v[68:71], a[36:39], a[100:103], v[68:71]
    s_waitcnt lgkmcnt(7)
    ds_read_b64 a[80:81], v250 offset:6656
    v_mul_f32 v237, v153, v49
    v_mfma_f32_16x16x32_bf16 v[208:211], a[40:43], v[240:243], v[208:211]
    s_add_u32 m0, s38, 117760
    ds_read_b128 a[28:31], v254 offset:320
    buffer_load_dwordx4 v252, s[28:31], m0 offen lds
    v_mfma_f32_16x16x32_bf16 v[64:67], a[44:47], a[104:107], v[64:67]
    s_waitcnt lgkmcnt(8)
    v_mul_f32 v245, v157, v53
    v_cvt_pk_bf16_f32 v237, v237, v245
    v_mfma_f32_16x16x32_bf16 v[220:223], a[0:3], v[240:243], v[220:223]
    s_waitcnt lgkmcnt(7)
    ds_read_b128 a[32:35], v249 offset:13312
    v_mul_f32 v238, v154, v50
    v_mfma_f32_16x16x32_bf16 v[68:71], a[4:7], a[104:107], v[68:71]
    s_waitcnt lgkmcnt(6)
    ds_read_b128 a[36:39], v248 offset:10240
    v_mul_f32 v244, v158, v54
    v_mfma_f32_16x16x32_bf16 v[216:219], a[8:11], v[240:243], v[216:219]
    s_add_u32 m0, s38, 121856
    ds_read_b128 a[40:43], v249 offset:13520
    buffer_load_dwordx4 v252, s[28:31], m0 offen lds
    v_mfma_f32_16x16x32_bf16 v[64:67], a[12:15], a[108:111], v[64:67]
    s_waitcnt lgkmcnt(7)
    ds_read_b128 a[44:47], v248 offset:14464
    v_cvt_pk_bf16_f32 v238, v238, v244
    v_mfma_f32_16x16x32_bf16 v[228:231], a[16:19], v[240:243], v[228:231]
    s_waitcnt lgkmcnt(7)
    ds_read_b128 a[0:3], v249 offset:13376
    v_mul_f32 v239, v155, v51
    v_mfma_f32_16x16x32_bf16 v[68:71], a[20:23], a[108:111], v[68:71]
    s_waitcnt lgkmcnt(6)
    ds_read_b128 a[4:7], v248 offset:18688
    v_mul_f32 v245, v159, v55
    v_mfma_f32_16x16x32_bf16 v[224:227], a[24:27], v[240:243], v[224:227]
    s_add_u32 m0, s38, 125952
    ds_read_b128 a[8:11], v249 offset:13584
    buffer_load_dwordx4 v252, s[28:31], m0 offen lds
    v_mfma_f32_16x16x32_bf16 v[64:67], a[80:83], a[120:123], v[64:67]
    s_waitcnt lgkmcnt(7)
    ds_read_b128 a[12:15], v254 offset:384
    v_cvt_pk_bf16_f32 v239, v239, v245
    v_mfma_f32_16x16x32_bf16 v[232:235], a[28:31], v[240:243], v[232:235]
    ds_read_b128 a[16:19], v249 offset:13440
    v_mul_f32 v240, v160, v56
    v_mfma_f32_16x16x32_bf16 v[68:71], a[80:83], a[124:127], v[68:71]
    s_waitcnt lgkmcnt(7)
    ds_read_b128 a[20:23], v248 offset:22144
    v_mul_f32 v244, v164, v60
    v_mfma_f32_16x16x32_bf16 v[72:75], a[32:35], a[100:103], v[72:75]
    s_add_u32 m0, s38, 143360
    ds_read_b128 a[24:27], v249 offset:13648
    buffer_load_dwordx4 v252, s[20:23], m0 offen lds
    v_mfma_f32_16x16x32_bf16 v[212:215], a[36:39], v[236:239], v[212:215]
    s_waitcnt lgkmcnt(8)
    ds_read_b128 a[28:31], v248 offset:26368
    v_cvt_pk_bf16_f32 v240, v240, v244
    v_mfma_f32_16x16x32_bf16 v[76:79], a[40:43], a[100:103], v[76:79]
    s_waitcnt lgkmcnt(8)
    ds_read_b64 a[84:85], v250 offset:13312
    v_mul_f32 v241, v161, v57
    v_mfma_f32_16x16x32_bf16 v[220:223], a[44:47], v[236:239], v[220:223]
    s_waitcnt lgkmcnt(8)
    ds_read_b128 a[32:35], v248 offset:30592
    v_mul_f32 v245, v165, v61
    v_mfma_f32_16x16x32_bf16 v[72:75], a[0:3], a[104:107], v[72:75]
    s_waitcnt vmcnt(13) lgkmcnt(7)
    v_cvt_pk_bf16_f32 v241, v241, v245
    v_mul_f32 v242, v162, v58
    v_mfma_f32_16x16x32_bf16 v[228:231], a[4:7], v[236:239], v[228:231]
    s_barrier
    ds_read_b128 a[36:39], v249 offset:19968
    v_mul_f32 v244, v166, v62
    v_mfma_f32_16x16x32_bf16 v[76:79], a[8:11], a[104:107], v[76:79]
    s_waitcnt lgkmcnt(5)
    ds_read_b128 a[40:43], v248 offset:22400
    v_cvt_pk_bf16_f32 v242, v242, v244
    v_mfma_f32_16x16x32_bf16 v[232:235], a[12:15], v[236:239], v[232:235]
    s_add_u32 s39, s38, 130048
    ds_read_b128 a[44:47], v249 offset:20176
    v_mul_f32 v243, v163, v59
    v_mfma_f32_16x16x32_bf16 v[72:75], a[16:19], a[108:111], v[72:75]
    s_mov_b32 m0, s50
    ds_read_b128 a[0:3], v248 offset:22656
    buffer_load_dwordx4 v252, s[28:31], s39 offen lds
    v_mfma_f32_16x16x32_bf16 v[208:211], a[20:23], v[236:239], v[208:211]
    s_waitcnt lgkmcnt(7)
    ds_read_b128 a[4:7], v249 offset:20032
    v_mul_f32 v245, v167, v63
    v_mfma_f32_16x16x32_bf16 v[76:79], a[24:27], a[108:111], v[76:79]
    s_waitcnt lgkmcnt(7)
    ds_read_b128 a[8:11], v248 offset:26624
    v_cvt_pk_bf16_f32 v243, v243, v245
    v_mfma_f32_16x16x32_bf16 v[216:219], a[28:31], v[236:239], v[216:219]
    s_waitcnt lgkmcnt(6)
    ds_read_b128 a[12:15], v249 offset:20240
    v_mfma_f32_16x16x32_bf16 v[72:75], a[84:87], a[120:123], v[72:75]
    s_add_u32 m0, s38, 67584
    ds_read_b128 a[16:19], v248 offset:26880
    buffer_load_dwordx4 v252, s[80:83], m0 offen lds
    v_mfma_f32_16x16x32_bf16 v[224:227], a[32:35], v[236:239], v[224:227]
    ds_read_b128 a[20:23], v249 offset:20096
    v_mul_f32 v236, v168, v64
    v_mfma_f32_16x16x32_bf16 v[76:79], a[84:87], a[124:127], v[76:79]
    s_waitcnt lgkmcnt(8)
    ds_read_b128 a[24:27], v248 offset:30848
    v_mul_f32 v244, v172, v68
    v_mfma_f32_16x16x32_bf16 v[80:83], a[36:39], a[100:103], v[80:83]
    s_waitcnt lgkmcnt(7)
    ds_read_b128 a[28:31], v249 offset:20304
    v_cvt_pk_bf16_f32 v236, v236, v244
    v_mfma_f32_16x16x32_bf16 v[212:215], a[40:43], v[240:243], v[212:215]
    s_add_u32 m0, s38, 71680
    ds_read_b128 a[32:35], v248 offset:31104
    buffer_load_dwordx4 v252, s[80:83], m0 offen lds
    v_mfma_f32_16x16x32_bf16 v[84:87], a[44:47], a[100:103], v[84:87]
    s_waitcnt lgkmcnt(8)
    ds_read_b64 a[88:89], v250 offset:19968
    v_mul_f32 v237, v169, v65
    v_mfma_f32_16x16x32_bf16 v[208:211], a[0:3], v[240:243], v[208:211]
    s_waitcnt lgkmcnt(8)
    ds_read_b128 a[36:39], v254 offset:448
    v_mul_f32 v245, v173, v69
    v_mfma_f32_16x16x32_bf16 v[80:83], a[4:7], a[104:107], v[80:83]
    s_waitcnt lgkmcnt(7)
    v_cvt_pk_bf16_f32 v237, v237, v245
    v_mul_f32 v238, v170, v66
    v_mfma_f32_16x16x32_bf16 v[220:223], a[8:11], v[240:243], v[220:223]
    s_add_u32 m0, s38, 75776
    ds_read_b128 a[40:43], v249 offset:26624
    buffer_load_dwordx4 v252, s[80:83], m0 offen lds
    v_mfma_f32_16x16x32_bf16 v[84:87], a[12:15], a[104:107], v[84:87]
    s_waitcnt lgkmcnt(7)
    ds_read_b128 a[44:47], v248 offset:22912
    v_mul_f32 v244, v174, v70
    v_mfma_f32_16x16x32_bf16 v[216:219], a[16:19], v[240:243], v[216:219]
    s_waitcnt lgkmcnt(7)
    ds_read_b128 a[0:3], v249 offset:26832
    v_cvt_pk_bf16_f32 v238, v238, v244
    v_mfma_f32_16x16x32_bf16 v[80:83], a[20:23], a[108:111], v[80:83]
    s_waitcnt lgkmcnt(6)
    ds_read_b128 a[4:7], v248 offset:27136
    v_mul_f32 v239, v171, v67
    v_mfma_f32_16x16x32_bf16 v[228:231], a[24:27], v[240:243], v[228:231]
    s_add_u32 m0, s38, 147456
    ds_read_b128 a[8:11], v249 offset:26688
    buffer_load_dwordx4 v252, s[20:23], m0 offen lds
    v_mfma_f32_16x16x32_bf16 v[84:87], a[28:31], a[108:111], v[84:87]
    s_waitcnt lgkmcnt(7)
    ds_read_b128 a[12:15], v248 offset:31360
    v_mul_f32 v245, v175, v71
    v_mfma_f32_16x16x32_bf16 v[224:227], a[32:35], v[240:243], v[224:227]
    s_waitcnt lgkmcnt(7)
    ds_read_b128 a[16:19], v249 offset:26896
    v_cvt_pk_bf16_f32 v239, v239, v245
    v_mfma_f32_16x16x32_bf16 v[80:83], a[88:91], a[120:123], v[80:83]
    s_waitcnt lgkmcnt(7)
    ds_read_b128 a[20:23], v254 offset:512
    v_mfma_f32_16x16x32_bf16 v[232:235], a[36:39], v[240:243], v[232:235]
    s_add_u32 m0, s38, 151552
    ds_read_b128 a[24:27], v249 offset:26752
    buffer_load_dwordx4 v252, s[20:23], m0 offen lds
    v_mfma_f32_16x16x32_bf16 v[84:87], a[88:91], a[124:127], v[84:87]
    s_waitcnt lgkmcnt(8)
    ds_read_b128 a[28:31], v248 offset:34816
    v_mul_f32 v240, v176, v72
    v_mfma_f32_16x16x32_bf16 v[88:91], a[40:43], a[100:103], v[88:91]
    s_waitcnt lgkmcnt(8)
    ds_read_b128 a[32:35], v249 offset:26960
    v_mul_f32 v244, v180, v76
    v_mfma_f32_16x16x32_bf16 v[212:215], a[44:47], v[236:239], v[212:215]
    s_waitcnt lgkmcnt(7)
    ds_read_b128 a[36:39], v248 offset:39040
    v_cvt_pk_bf16_f32 v240, v240, v244
    v_mfma_f32_16x16x32_bf16 v[92:95], a[0:3], a[100:103], v[92:95]
    s_add_u32 m0, s38, 155648
    ds_read_b64 a[92:93], v250 offset:26624
    buffer_load_dwordx4 v252, s[20:23], m0 offen lds
    v_mfma_f32_16x16x32_bf16 v[220:223], a[4:7], v[236:239], v[220:223]
    s_waitcnt lgkmcnt(8)
    ds_read_b128 a[40:43], v248 offset:43264
    v_mul_f32 v241, v177, v73
    v_mfma_f32_16x16x32_bf16 v[88:91], a[8:11], a[104:107], v[88:91]
    s_waitcnt vmcnt(15) lgkmcnt(6)
    v_mul_f32 v245, v181, v77
    v_cvt_pk_bf16_f32 v241, v241, v245
    v_mfma_f32_16x16x32_bf16 v[228:231], a[12:15], v[236:239], v[228:231]
    s_barrier
    ds_read_b128 a[44:47], v249 offset:33280
    v_mul_f32 v242, v178, v74
    v_mfma_f32_16x16x32_bf16 v[92:95], a[16:19], a[104:107], v[92:95]
    s_add_u32 m0, s38, 79872
    ds_read_b128 a[0:3], v248 offset:35072
    buffer_load_dwordx4 v252, s[80:83], m0 offen lds
    v_mfma_f32_16x16x32_bf16 v[232:235], a[20:23], v[236:239], v[232:235]
    s_waitcnt lgkmcnt(7)
    ds_read_b128 a[4:7], v249 offset:33488
    v_mul_f32 v244, v182, v78
    v_mfma_f32_16x16x32_bf16 v[88:91], a[24:27], a[108:111], v[88:91]
    s_waitcnt lgkmcnt(7)
    ds_read_b128 a[8:11], v248 offset:35328
    v_cvt_pk_bf16_f32 v242, v242, v244
    v_mfma_f32_16x16x32_bf16 v[208:211], a[28:31], v[236:239], v[208:211]
    s_waitcnt lgkmcnt(6)
    ds_read_b128 a[12:15], v249 offset:33344
    v_mul_f32 v243, v179, v75
    v_mfma_f32_16x16x32_bf16 v[92:95], a[32:35], a[108:111], v[92:95]
    s_add_u32 m0, s38, 83968
    ds_read_b128 a[16:19], v248 offset:39296
    buffer_load_dwordx4 v252, s[80:83], m0 offen lds
    v_mfma_f32_16x16x32_bf16 v[216:219], a[36:39], v[236:239], v[216:219]
    s_waitcnt lgkmcnt(7)
    ds_read_b128 a[20:23], v249 offset:33552
    v_mul_f32 v245, v183, v79
    v_mfma_f32_16x16x32_bf16 v[88:91], a[92:95], a[120:123], v[88:91]
    s_waitcnt lgkmcnt(7)
    ds_read_b128 a[24:27], v248 offset:39552
    v_cvt_pk_bf16_f32 v243, v243, v245
    v_mfma_f32_16x16x32_bf16 v[224:227], a[40:43], v[236:239], v[224:227]
    s_waitcnt lgkmcnt(7)
    ds_read_b128 a[28:31], v249 offset:33408
    v_mul_f32 v236, v184, v80
    v_mfma_f32_16x16x32_bf16 v[92:95], a[92:95], a[124:127], v[92:95]
    s_add_u32 m0, s38, 88064
    ds_read_b128 a[32:35], v248 offset:43520
    buffer_load_dwordx4 v252, s[80:83], m0 offen lds
    v_mfma_f32_16x16x32_bf16 v[96:99], a[44:47], a[100:103], v[96:99]
    s_waitcnt lgkmcnt(8)
    ds_read_b128 a[36:39], v249 offset:33616
    v_mul_f32 v244, v188, v84
    v_mfma_f32_16x16x32_bf16 v[212:215], a[0:3], v[240:243], v[212:215]
    s_waitcnt lgkmcnt(8)
    ds_read_b128 a[40:43], v248 offset:43776
    v_cvt_pk_bf16_f32 v236, v236, v244
    v_mfma_f32_16x16x32_bf16 v[100:103], a[4:7], a[100:103], v[100:103]
    s_waitcnt lgkmcnt(7)
    ds_read_b64 a[96:97], v250 offset:33280
    v_mul_f32 v237, v185, v81
    v_mfma_f32_16x16x32_bf16 v[208:211], a[8:11], v[240:243], v[208:211]
    s_add_u32 m0, s38, 159744
    ds_read_b128 a[44:47], v254 offset:576
    buffer_load_dwordx4 v252, s[20:23], m0 offen lds
    v_mfma_f32_16x16x32_bf16 v[96:99], a[12:15], a[104:107], v[96:99]
    s_waitcnt lgkmcnt(8)
    v_mul_f32 v245, v189, v85
    v_cvt_pk_bf16_f32 v237, v237, v245
    v_mfma_f32_16x16x32_bf16 v[220:223], a[16:19], v[240:243], v[220:223]
    s_waitcnt lgkmcnt(7)
    ds_read_b128 a[0:3], v248 offset:35584
    v_mul_f32 v238, v186, v82
    v_mfma_f32_16x16x32_bf16 v[100:103], a[20:23], a[104:107], v[100:103]
    s_waitcnt lgkmcnt(7)
    ds_read_b128 a[4:7], v248 offset:39808
    v_mul_f32 v244, v190, v86
    v_mfma_f32_16x16x32_bf16 v[216:219], a[24:27], v[240:243], v[216:219]
    s_waitcnt lgkmcnt(7)
    ds_read_b128 a[8:11], v248 offset:44032
    v_cvt_pk_bf16_f32 v238, v238, v244
    v_mfma_f32_16x16x32_bf16 v[96:99], a[28:31], a[108:111], v[96:99]
    s_waitcnt lgkmcnt(7)
    ds_read_b128 a[12:15], v254 offset:640
    v_mul_f32 v239, v187, v83
    v_mfma_f32_16x16x32_bf16 v[228:231], a[32:35], v[240:243], v[228:231]
    s_waitcnt lgkmcnt(7)
    ds_read_b128 a[16:19], v248 offset:47488
    v_mul_f32 v245, v191, v87
    v_mfma_f32_16x16x32_bf16 v[100:103], a[36:39], a[108:111], v[100:103]
    s_waitcnt lgkmcnt(7)
    ds_read_b128 a[20:23], v248 offset:51712
    v_cvt_pk_bf16_f32 v239, v239, v245
    v_mfma_f32_16x16x32_bf16 v[224:227], a[40:43], v[240:243], v[224:227]
    s_waitcnt lgkmcnt(7)
    ds_read_b128 a[24:27], v248 offset:55936
    v_mfma_f32_16x16x32_bf16 v[96:99], a[96:99], a[120:123], v[96:99]
    s_waitcnt lgkmcnt(7)
    ds_read_b128 a[28:31], v248 offset:47744
    v_mfma_f32_16x16x32_bf16 v[232:235], a[44:47], v[240:243], v[232:235]
    ds_read_b128 a[32:35], v248 offset:48000
    v_mul_f32 v240, v192, v88
    v_mfma_f32_16x16x32_bf16 v[100:103], a[96:99], a[124:127], v[100:103]
    s_waitcnt lgkmcnt(8)
    ds_read_b128 a[36:39], v248 offset:51968
    v_mul_f32 v244, v196, v92
    v_mfma_f32_16x16x32_bf16 v[212:215], a[0:3], v[236:239], v[212:215]
    s_waitcnt vmcnt(10) lgkmcnt(6)
    ds_read_b128 a[40:43], v248 offset:52224
    v_cvt_pk_bf16_f32 v240, v240, v244
    v_mfma_f32_16x16x32_bf16 v[220:223], a[4:7], v[236:239], v[220:223]
    s_barrier
    ds_read_b128 a[44:47], v248 offset:56192
    v_mul_f32 v241, v193, v89
    v_mfma_f32_16x16x32_bf16 v[228:231], a[8:11], v[236:239], v[228:231]
    s_add_u32 m0, s38, 92160
    ds_read_b128 a[0:3], v248 offset:56448
    buffer_load_dwordx4 v252, s[80:83], m0 offen lds
    v_mul_f32 v245, v197, v93
    v_cvt_pk_bf16_f32 v241, v241, v245
    v_mfma_f32_16x16x32_bf16 v[232:235], a[12:15], v[236:239], v[232:235]
    s_waitcnt lgkmcnt(8)
    ds_read_b128 a[4:7], v254 offset:704
    v_mul_f32 v242, v194, v90
    v_mul_f32 v244, v198, v94
    v_mfma_f32_16x16x32_bf16 v[208:211], a[16:19], v[236:239], v[208:211]
    s_waitcnt lgkmcnt(8)
    ds_read_b128 a[8:11], v248 offset:48256
    v_cvt_pk_bf16_f32 v242, v242, v244
    v_mul_f32 v243, v195, v91
    v_mfma_f32_16x16x32_bf16 v[216:219], a[20:23], v[236:239], v[216:219]
    s_waitcnt lgkmcnt(7)
    ds_read_b128 a[12:15], v248 offset:60160
    v_mul_f32 v245, v199, v95
    v_cvt_pk_bf16_f32 v243, v243, v245
    v_mfma_f32_16x16x32_bf16 v[224:227], a[24:27], v[236:239], v[224:227]
    s_add_u32 m0, s38, 96256
    ds_read_b128 a[16:19], v248 offset:52480
    buffer_load_dwordx4 v252, s[80:83], m0 offen lds
    v_mfma_f32_16x16x32_bf16 v[212:215], a[28:31], v[240:243], v[212:215]
    s_waitcnt lgkmcnt(8)
    ds_read_b128 a[20:23], v248 offset:60672
    v_mul_f32 v236, v200, v96
    v_mul_f32 v244, v204, v100
    v_mfma_f32_16x16x32_bf16 v[208:211], a[32:35], v[240:243], v[208:211]
    s_waitcnt lgkmcnt(8)
    ds_read_b128 a[24:27], v248 offset:56704
    v_cvt_pk_bf16_f32 v236, v236, v244
    v_mul_f32 v237, v201, v97
    v_mfma_f32_16x16x32_bf16 v[220:223], a[36:39], v[240:243], v[220:223]
    s_waitcnt lgkmcnt(7)
    ds_read_b128 a[28:31], v248 offset:1024
    v_mul_f32 v245, v205, v101
    v_cvt_pk_bf16_f32 v237, v237, v245
    v_mfma_f32_16x16x32_bf16 v[216:219], a[40:43], v[240:243], v[216:219]
    s_add_u32 m0, s38, 100352
    ds_read_b128 a[32:35], v254 offset:768
    buffer_load_dwordx4 v252, s[80:83], m0 offen lds
    v_mul_f32 v238, v202, v98
    v_mul_f32 v244, v206, v102
    v_mfma_f32_16x16x32_bf16 v[228:231], a[44:47], v[240:243], v[228:231]
    s_waitcnt lgkmcnt(8)
    ds_read_b128 a[36:39], v249 offset:39936
    v_cvt_pk_bf16_f32 v238, v238, v244
    v_mul_f32 v239, v203, v99
    v_mfma_f32_16x16x32_bf16 v[224:227], a[0:3], v[240:243], v[224:227]
    s_waitcnt lgkmcnt(6)
    ds_read_b128 a[40:43], v249 offset:40144
    v_mul_f32 v245, v207, v103
    v_cvt_pk_bf16_f32 v239, v239, v245
    v_mfma_f32_16x16x32_bf16 v[232:235], a[4:7], v[240:243], v[232:235]
    s_add_u32 s39, s38, 104448
    ds_read_b128 a[44:47], v249 offset:46592
    v_mfma_f32_16x16x32_bf16 v[212:215], a[8:11], v[236:239], v[212:215]
    s_mov_b32 m0, s84
    ds_read_b128 a[0:3], v249 offset:46800
    buffer_load_dwordx4 v252, s[80:83], s39 offen lds
    v_mfma_f32_16x16x32_bf16 v[208:211], a[12:15], v[236:239], v[208:211]
    s_waitcnt lgkmcnt(8)
    ds_read_b128 a[4:7], v249 offset:40000
    v_mfma_f32_16x16x32_bf16 v[220:223], a[16:19], v[236:239], v[220:223]
    s_waitcnt lgkmcnt(8)
    ds_read_b128 a[8:11], v249 offset:40208
    v_mfma_f32_16x16x32_bf16 v[216:219], a[20:23], v[236:239], v[216:219]
    s_waitcnt lgkmcnt(8)
    ds_read_b128 a[12:15], v249 offset:46656
    v_cvt_pk_bf16_f32 v208, v208, v212
    v_cvt_pk_bf16_f32 v209, v209, v213
    v_cvt_pk_bf16_f32 v210, v210, v214
    v_mfma_f32_16x16x32_bf16 v[228:231], a[24:27], v[236:239], v[228:231]
    s_waitcnt lgkmcnt(8)
    ds_read_b128 a[16:19], v249 offset:46864
    v_cvt_pk_bf16_f32 v211, v211, v215
    v_accvgpr_write_b32 a100, v208
    v_accvgpr_write_b32 a101, v209
    v_mfma_f32_16x16x32_bf16 v[224:227], a[28:31], v[236:239], v[224:227]
    s_waitcnt lgkmcnt(8)
    ds_read_b128 a[20:23], v249 offset:40064
    v_accvgpr_write_b32 a102, v210
    v_accvgpr_write_b32 a103, v211
    v_mfma_f32_16x16x32_bf16 v[232:235], a[32:35], v[236:239], v[232:235]
    s_waitcnt lgkmcnt(8)
    ds_read_b128 a[24:27], v249 offset:40272
    v_cvt_pk_bf16_f32 v216, v216, v220
    v_cvt_pk_bf16_f32 v217, v217, v221
    v_mfma_f32_16x16x32_bf16 v[0:3], a[36:39], a[100:103], v[0:3]
    s_waitcnt lgkmcnt(8)
    ds_read_b128 a[28:31], v249 offset:46720
    v_cvt_pk_bf16_f32 v218, v218, v222
    v_cvt_pk_bf16_f32 v219, v219, v223
    v_mfma_f32_16x16x32_bf16 v[4:7], a[40:43], a[100:103], v[4:7]
    s_waitcnt lgkmcnt(8)
    ds_read_b128 a[32:35], v249 offset:46928
    v_accvgpr_write_b32 a104, v216
    v_accvgpr_write_b32 a105, v217
    v_mfma_f32_16x16x32_bf16 v[8:11], a[44:47], a[100:103], v[8:11]
    s_waitcnt lgkmcnt(8)
    ds_read_b64 a[48:49], v250 offset:39936
    v_accvgpr_write_b32 a106, v218
    v_accvgpr_write_b32 a107, v219
    v_mfma_f32_16x16x32_bf16 v[12:15], a[0:3], a[100:103], v[12:15]
    s_waitcnt lgkmcnt(8)
    v_cvt_pk_bf16_f32 v224, v224, v228
    v_cvt_pk_bf16_f32 v225, v225, v229
    v_mfma_f32_16x16x32_bf16 v[0:3], a[4:7], a[104:107], v[0:3]
    s_waitcnt lgkmcnt(7)
    ds_read_b64 a[52:53], v250 offset:46592
    v_cvt_pk_bf16_f32 v226, v226, v230
    v_cvt_pk_bf16_f32 v227, v227, v231
    v_mfma_f32_16x16x32_bf16 v[4:7], a[8:11], a[104:107], v[4:7]
    s_waitcnt lgkmcnt(7)
    v_accvgpr_write_b32 a108, v224
    v_accvgpr_write_b32 a109, v225
    v_mfma_f32_16x16x32_bf16 v[8:11], a[12:15], a[104:107], v[8:11]
    s_waitcnt lgkmcnt(6)
    ds_read_b128 a[36:39], v249 offset:53248
    v_accvgpr_write_b32 a110, v226
    v_accvgpr_write_b32 a111, v227
    v_mfma_f32_16x16x32_bf16 v[12:15], a[16:19], a[104:107], v[12:15]
    s_waitcnt lgkmcnt(6)
    ds_read_b128 a[40:43], v249 offset:53456
    v_cvt_pk_bf16_f32 v232, v232, v233
    v_mfma_f32_16x16x32_bf16 v[0:3], a[20:23], a[108:111], v[0:3]
    s_waitcnt lgkmcnt(6)
    ds_read_b128 a[44:47], v249 offset:53312
    v_cvt_pk_bf16_f32 v233, v234, v235
    v_mfma_f32_16x16x32_bf16 v[4:7], a[24:27], a[108:111], v[4:7]
    s_waitcnt lgkmcnt(6)
    ds_read_b128 a[0:3], v249 offset:53520
    v_cndmask_b32 v234, 0, v232, s[40:41]
    v_cndmask_b32 v235, 0, v233, s[40:41]
    v_mfma_f32_16x16x32_bf16 v[8:11], a[28:31], a[108:111], v[8:11]
    s_waitcnt lgkmcnt(6)
    ds_read_b128 a[4:7], v249 offset:53376
    v_accvgpr_write_b32 a128, v234
    v_accvgpr_write_b32 a129, v235
    v_cndmask_b32 v232, v232, 0, s[40:41]
    v_mfma_f32_16x16x32_bf16 v[12:15], a[32:35], a[108:111], v[12:15]
    s_waitcnt lgkmcnt(6)
    ds_read_b128 a[8:11], v249 offset:53584
    v_cndmask_b32 v233, v233, 0, s[40:41]
    v_accvgpr_write_b32 a132, v232
    v_accvgpr_write_b32 a133, v233
    v_mfma_f32_16x16x32_bf16 v[0:3], a[48:51], a[128:131], v[0:3]
    ds_read_b64 a[56:57], v250 offset:53248
    v_mfma_f32_16x16x32_bf16 v[4:7], a[48:51], a[132:135], v[4:7]
    s_waitcnt lgkmcnt(7)
    v_mfma_f32_16x16x32_bf16 v[8:11], a[52:55], a[128:131], v[8:11]
    ds_read_b128 a[12:15], v249 offset:59904
    v_mul_f32 v236, v104, v0
    v_mfma_f32_16x16x32_bf16 v[12:15], a[52:55], a[132:135], v[12:15]
    s_waitcnt lgkmcnt(7)
    ds_read_b128 a[16:19], v249 offset:60112
    v_mul_f32 v244, v108, v4
    v_mfma_f32_16x16x32_bf16 v[16:19], a[36:39], a[100:103], v[16:19]
    s_waitcnt lgkmcnt(7)
    ds_read_b128 a[20:23], v249 offset:59968
    v_cvt_pk_bf16_f32 v236, v236, v244
    v_mfma_f32_16x16x32_bf16 v[20:23], a[40:43], a[100:103], v[20:23]
    s_waitcnt lgkmcnt(7)
    ds_read_b128 a[24:27], v249 offset:60176
    v_mul_f32 v237, v105, v1
    v_mfma_f32_16x16x32_bf16 v[16:19], a[44:47], a[104:107], v[16:19]
    s_waitcnt lgkmcnt(7)
    ds_read_b128 a[28:31], v249 offset:60032
    v_mul_f32 v245, v109, v5
    v_mfma_f32_16x16x32_bf16 v[20:23], a[0:3], a[104:107], v[20:23]
    s_waitcnt lgkmcnt(7)
    ds_read_b128 a[32:35], v249 offset:60240
    v_cvt_pk_bf16_f32 v237, v237, v245
    v_mfma_f32_16x16x32_bf16 v[16:19], a[4:7], a[108:111], v[16:19]
    s_waitcnt lgkmcnt(7)
    ds_read_b64 a[60:61], v250 offset:59904
    v_mul_f32 v238, v106, v2
    v_mul_f32 v244, v110, v6
    v_mfma_f32_16x16x32_bf16 v[20:23], a[8:11], a[108:111], v[20:23]
    s_waitcnt vmcnt(3) lgkmcnt(7)
    v_cvt_pk_bf16_f32 v238, v238, v244
    v_mul_f32 v239, v107, v3
    v_mfma_f32_16x16x32_bf16 v[16:19], a[56:59], a[128:131], v[16:19]
    s_barrier
    ds_read_b128 a[36:39], v249 offset:0
    v_mul_f32 v245, v111, v7
    v_cvt_pk_bf16_f32 v239, v239, v245
    v_mul_f32 v240, v112, v8
    v_mfma_f32_16x16x32_bf16 v[20:23], a[56:59], a[132:135], v[20:23]
    s_waitcnt lgkmcnt(7)
    ds_read_b128 a[40:43], v249 offset:208
    buffer_store_dwordx4 v[236:239], v253, s[32:35], 0 offen offset:0 sc1
    v_mul_f32 v244, v116, v12
    v_cvt_pk_bf16_f32 v240, v240, v244
    v_mfma_f32_16x16x32_bf16 v[24:27], a[12:15], a[100:103], v[24:27]
    s_waitcnt lgkmcnt(7)
    ds_read_b128 a[44:47], v249 offset:64
    v_mul_f32 v241, v113, v9
    v_mul_f32 v245, v117, v13
    v_cvt_pk_bf16_f32 v241, v241, v245
    v_mul_f32 v242, v114, v10
    v_mul_f32 v244, v118, v14
    v_cvt_pk_bf16_f32 v242, v242, v244
    v_mul_f32 v243, v115, v11
    v_mul_f32 v245, v119, v15
    v_cvt_pk_bf16_f32 v243, v243, v245
    v_mfma_f32_16x16x32_bf16 v[28:31], a[16:19], a[100:103], v[28:31]
    s_waitcnt lgkmcnt(7)
    ds_read_b128 a[0:3], v249 offset:272
    buffer_store_dwordx4 v[240:243], v253, s[32:35], 0 offen offset:64 sc1
    v_mfma_f32_16x16x32_bf16 v[24:27], a[20:23], a[104:107], v[24:27]
    s_waitcnt lgkmcnt(7)
    ds_read_b128 a[4:7], v249 offset:128
    v_mul_f32 v208, v120, v16
    v_mfma_f32_16x16x32_bf16 v[28:31], a[24:27], a[104:107], v[28:31]
    s_waitcnt lgkmcnt(7)
    ds_read_b128 a[8:11], v249 offset:336
    v_mul_f32 v244, v124, v20
    v_mfma_f32_16x16x32_bf16 v[24:27], a[28:31], a[108:111], v[24:27]
    s_waitcnt lgkmcnt(7)
    ds_read_b64 a[64:65], v250 offset:0
    v_cvt_pk_bf16_f32 v208, v208, v244
    v_mul_f32 v209, v121, v17
    v_mfma_f32_16x16x32_bf16 v[28:31], a[32:35], a[108:111], v[28:31]
    s_waitcnt lgkmcnt(7)
    v_mul_f32 v245, v125, v21
    v_cvt_pk_bf16_f32 v209, v209, v245
    v_mfma_f32_16x16x32_bf16 v[24:27], a[60:63], a[128:131], v[24:27]
    ds_read_b128 a[12:15], v249 offset:6656
    v_mul_f32 v210, v122, v18
    v_mul_f32 v244, v126, v22
    v_mfma_f32_16x16x32_bf16 v[28:31], a[60:63], a[132:135], v[28:31]
    s_waitcnt lgkmcnt(7)
    ds_read_b128 a[16:19], v249 offset:6864
    v_cvt_pk_bf16_f32 v210, v210, v244
    v_mul_f32 v211, v123, v19
    v_mfma_f32_16x16x32_bf16 v[32:35], a[36:39], a[100:103], v[32:35]
    s_waitcnt lgkmcnt(7)
    ds_read_b128 a[20:23], v249 offset:6720
    v_mul_f32 v245, v127, v23
    v_cvt_pk_bf16_f32 v211, v211, v245
    v_mfma_f32_16x16x32_bf16 v[36:39], a[40:43], a[100:103], v[36:39]
    s_waitcnt lgkmcnt(7)
    ds_read_b128 a[24:27], v249 offset:6928
    buffer_store_dwordx4 v[208:211], v253, s[32:35], 0 offen offset:128 sc1
    v_mfma_f32_16x16x32_bf16 v[32:35], a[44:47], a[104:107], v[32:35]
    s_waitcnt lgkmcnt(7)
    ds_read_b128 a[28:31], v249 offset:6784
    v_mul_f32 v212, v128, v24
    v_mfma_f32_16x16x32_bf16 v[36:39], a[0:3], a[104:107], v[36:39]
    s_waitcnt lgkmcnt(7)
    ds_read_b128 a[32:35], v249 offset:6992
    v_mul_f32 v244, v132, v28
    v_mfma_f32_16x16x32_bf16 v[32:35], a[4:7], a[108:111], v[32:35]
    s_waitcnt lgkmcnt(7)
    ds_read_b64 a[68:69], v250 offset:6656
    v_cvt_pk_bf16_f32 v212, v212, v244
    v_mul_f32 v213, v129, v25
    v_mfma_f32_16x16x32_bf16 v[36:39], a[8:11], a[108:111], v[36:39]
    s_waitcnt lgkmcnt(7)
    v_mul_f32 v245, v133, v29
    v_cvt_pk_bf16_f32 v213, v213, v245
    v_mfma_f32_16x16x32_bf16 v[32:35], a[64:67], a[128:131], v[32:35]
    ds_read_b128 a[36:39], v249 offset:13312
    v_mul_f32 v214, v130, v26
    v_mul_f32 v244, v134, v30
    v_mfma_f32_16x16x32_bf16 v[36:39], a[64:67], a[132:135], v[36:39]
    s_waitcnt lgkmcnt(7)
    ds_read_b128 a[40:43], v249 offset:13520
    v_cvt_pk_bf16_f32 v214, v214, v244
    v_mul_f32 v215, v131, v27
    v_mfma_f32_16x16x32_bf16 v[40:43], a[12:15], a[100:103], v[40:43]
    s_waitcnt lgkmcnt(7)
    ds_read_b128 a[44:47], v249 offset:13376
    v_mul_f32 v245, v135, v31
    v_cvt_pk_bf16_f32 v215, v215, v245
    v_mfma_f32_16x16x32_bf16 v[44:47], a[16:19], a[100:103], v[44:47]
    s_waitcnt lgkmcnt(7)
    ds_read_b128 a[0:3], v249 offset:13584
    buffer_store_dwordx4 v[212:215], v253, s[32:35], 0 offen offset:192 sc1
    v_mfma_f32_16x16x32_bf16 v[40:43], a[20:23], a[104:107], v[40:43]
    s_waitcnt lgkmcnt(7)
    ds_read_b128 a[4:7], v249 offset:13440
    v_mul_f32 v216, v136, v32
    v_mfma_f32_16x16x32_bf16 v[44:47], a[24:27], a[104:107], v[44:47]
    s_waitcnt lgkmcnt(7)
    ds_read_b128 a[8:11], v249 offset:13648
    v_mul_f32 v244, v140, v36
    v_mfma_f32_16x16x32_bf16 v[40:43], a[28:31], a[108:111], v[40:43]
    s_waitcnt lgkmcnt(7)
    ds_read_b64 a[72:73], v250 offset:13312
    v_cvt_pk_bf16_f32 v216, v216, v244
    v_mul_f32 v217, v137, v33
    v_mfma_f32_16x16x32_bf16 v[44:47], a[32:35], a[108:111], v[44:47]
    s_waitcnt lgkmcnt(7)
    v_mul_f32 v245, v141, v37
    v_cvt_pk_bf16_f32 v217, v217, v245
    v_mfma_f32_16x16x32_bf16 v[40:43], a[68:71], a[128:131], v[40:43]
    ds_read_b128 a[12:15], v249 offset:19968
    v_mul_f32 v218, v138, v34
    v_mul_f32 v244, v142, v38
    v_mfma_f32_16x16x32_bf16 v[44:47], a[68:71], a[132:135], v[44:47]
    s_waitcnt lgkmcnt(7)
    ds_read_b128 a[16:19], v249 offset:20176
    v_cvt_pk_bf16_f32 v218, v218, v244
    v_mul_f32 v219, v139, v35
    v_mfma_f32_16x16x32_bf16 v[48:51], a[36:39], a[100:103], v[48:51]
    s_waitcnt lgkmcnt(7)
    ds_read_b128 a[20:23], v249 offset:20032
    v_mul_f32 v245, v143, v39
    v_cvt_pk_bf16_f32 v219, v219, v245
    v_mfma_f32_16x16x32_bf16 v[52:55], a[40:43], a[100:103], v[52:55]
    s_waitcnt lgkmcnt(7)
    ds_read_b128 a[24:27], v249 offset:20240
    buffer_store_dwordx4 v[216:219], v253, s[32:35], 0 offen offset:256 sc1
    v_mfma_f32_16x16x32_bf16 v[48:51], a[44:47], a[104:107], v[48:51]
    s_waitcnt lgkmcnt(7)
    ds_read_b128 a[28:31], v249 offset:20096
    v_mul_f32 v220, v144, v40
    v_mfma_f32_16x16x32_bf16 v[52:55], a[0:3], a[104:107], v[52:55]
    s_waitcnt lgkmcnt(7)
    ds_read_b128 a[32:35], v249 offset:20304
    v_mul_f32 v244, v148, v44
    v_mfma_f32_16x16x32_bf16 v[48:51], a[4:7], a[108:111], v[48:51]
    s_waitcnt lgkmcnt(7)
    ds_read_b64 a[76:77], v250 offset:19968
    v_cvt_pk_bf16_f32 v220, v220, v244
    v_mul_f32 v221, v145, v41
    v_mfma_f32_16x16x32_bf16 v[52:55], a[8:11], a[108:111], v[52:55]
    s_waitcnt vmcnt(5) lgkmcnt(7)
    v_mul_f32 v245, v149, v45
    v_cvt_pk_bf16_f32 v221, v221, v245
    v_mfma_f32_16x16x32_bf16 v[48:51], a[72:75], a[128:131], v[48:51]
    s_barrier
    ds_read_b128 a[36:39], v249 offset:26624
    v_mul_f32 v222, v146, v42
    v_mul_f32 v244, v150, v46
    v_mfma_f32_16x16x32_bf16 v[52:55], a[72:75], a[132:135], v[52:55]
    s_waitcnt lgkmcnt(7)
    ds_read_b128 a[40:43], v249 offset:26832
    v_cvt_pk_bf16_f32 v222, v222, v244
    v_mul_f32 v223, v147, v43
    v_mfma_f32_16x16x32_bf16 v[56:59], a[12:15], a[100:103], v[56:59]
    s_waitcnt lgkmcnt(7)
    ds_read_b128 a[44:47], v249 offset:26688
    v_mul_f32 v245, v151, v47
    v_cvt_pk_bf16_f32 v223, v223, v245
    v_mfma_f32_16x16x32_bf16 v[60:63], a[16:19], a[100:103], v[60:63]
    s_waitcnt lgkmcnt(7)
    ds_read_b128 a[0:3], v249 offset:26896
    buffer_store_dwordx4 v[220:223], v253, s[32:35], 0 offen offset:320 sc1
    v_mfma_f32_16x16x32_bf16 v[56:59], a[20:23], a[104:107], v[56:59]
    s_waitcnt lgkmcnt(7)
    ds_read_b128 a[4:7], v249 offset:26752
    v_mul_f32 v224, v152, v48
    v_mfma_f32_16x16x32_bf16 v[60:63], a[24:27], a[104:107], v[60:63]
    s_waitcnt lgkmcnt(7)
    ds_read_b128 a[8:11], v249 offset:26960
    v_mul_f32 v244, v156, v52
    v_mfma_f32_16x16x32_bf16 v[56:59], a[28:31], a[108:111], v[56:59]
    s_waitcnt lgkmcnt(7)
    ds_read_b64 a[80:81], v250 offset:26624
    v_cvt_pk_bf16_f32 v224, v224, v244
    v_mul_f32 v225, v153, v49
    v_mfma_f32_16x16x32_bf16 v[60:63], a[32:35], a[108:111], v[60:63]
    s_waitcnt lgkmcnt(7)
    v_mul_f32 v245, v157, v53
    v_cvt_pk_bf16_f32 v225, v225, v245
    v_mfma_f32_16x16x32_bf16 v[56:59], a[76:79], a[128:131], v[56:59]
    ds_read_b128 a[12:15], v249 offset:33280
    v_mul_f32 v226, v154, v50
    v_mul_f32 v244, v158, v54
    v_mfma_f32_16x16x32_bf16 v[60:63], a[76:79], a[132:135], v[60:63]
    s_waitcnt lgkmcnt(7)
    ds_read_b128 a[16:19], v249 offset:33488
    v_cvt_pk_bf16_f32 v226, v226, v244
    v_mul_f32 v227, v155, v51
    v_mfma_f32_16x16x32_bf16 v[64:67], a[36:39], a[100:103], v[64:67]
    s_waitcnt lgkmcnt(7)
    ds_read_b128 a[20:23], v249 offset:33344
    v_mul_f32 v245, v159, v55
    v_cvt_pk_bf16_f32 v227, v227, v245
    v_mfma_f32_16x16x32_bf16 v[68:71], a[40:43], a[100:103], v[68:71]
    s_waitcnt lgkmcnt(7)
    ds_read_b128 a[24:27], v249 offset:33552
    buffer_store_dwordx4 v[224:227], v253, s[32:35], 0 offen offset:384 sc1
    v_mfma_f32_16x16x32_bf16 v[64:67], a[44:47], a[104:107], v[64:67]
    s_waitcnt lgkmcnt(7)
    ds_read_b128 a[28:31], v249 offset:33408
    v_mul_f32 v228, v160, v56
    v_mfma_f32_16x16x32_bf16 v[68:71], a[0:3], a[104:107], v[68:71]
    s_waitcnt lgkmcnt(7)
    ds_read_b128 a[32:35], v249 offset:33616
    v_add_u32 v249, 74752, v249
    v_mul_f32 v244, v164, v60
    v_mfma_f32_16x16x32_bf16 v[64:67], a[4:7], a[108:111], v[64:67]
    s_waitcnt lgkmcnt(7)
    ds_read_b64 a[84:85], v250 offset:33280
    v_add_u32 v250, 74752, v250
    v_cvt_pk_bf16_f32 v228, v228, v244
    v_mul_f32 v229, v161, v57
    v_mfma_f32_16x16x32_bf16 v[68:71], a[8:11], a[108:111], v[68:71]
    s_waitcnt lgkmcnt(7)
    v_mul_f32 v245, v165, v61
    v_cvt_pk_bf16_f32 v229, v229, v245
    v_mfma_f32_16x16x32_bf16 v[64:67], a[80:83], a[128:131], v[64:67]
    ds_read_b128 a[36:39], v249 offset:0
    v_mul_f32 v230, v162, v58
    v_mul_f32 v244, v166, v62
    v_mfma_f32_16x16x32_bf16 v[68:71], a[80:83], a[132:135], v[68:71]
    s_waitcnt lgkmcnt(7)
    ds_read_b128 a[40:43], v249 offset:208
    v_cvt_pk_bf16_f32 v230, v230, v244
    v_mul_f32 v231, v163, v59
    v_mfma_f32_16x16x32_bf16 v[72:75], a[12:15], a[100:103], v[72:75]
    s_waitcnt lgkmcnt(7)
    ds_read_b128 a[44:47], v249 offset:64
    v_mul_f32 v245, v167, v63
    v_cvt_pk_bf16_f32 v231, v231, v245
    v_mfma_f32_16x16x32_bf16 v[76:79], a[16:19], a[100:103], v[76:79]
    s_waitcnt lgkmcnt(7)
    ds_read_b128 a[0:3], v249 offset:272
    buffer_store_dwordx4 v[228:231], v253, s[32:35], 0 offen offset:448 sc1
    v_mfma_f32_16x16x32_bf16 v[72:75], a[20:23], a[104:107], v[72:75]
    s_waitcnt lgkmcnt(7)
    ds_read_b128 a[4:7], v249 offset:128
    v_mul_f32 v232, v168, v64
    v_mfma_f32_16x16x32_bf16 v[76:79], a[24:27], a[104:107], v[76:79]
    s_waitcnt lgkmcnt(7)
    ds_read_b128 a[8:11], v249 offset:336
    v_mul_f32 v244, v172, v68
    v_mfma_f32_16x16x32_bf16 v[72:75], a[28:31], a[108:111], v[72:75]
    s_waitcnt lgkmcnt(7)
    ds_read_b64 a[88:89], v250 offset:0
    v_cvt_pk_bf16_f32 v232, v232, v244
    v_mul_f32 v233, v169, v65
    v_mfma_f32_16x16x32_bf16 v[76:79], a[32:35], a[108:111], v[76:79]
    s_waitcnt lgkmcnt(7)
    v_mul_f32 v245, v173, v69
    v_cvt_pk_bf16_f32 v233, v233, v245
    v_mfma_f32_16x16x32_bf16 v[72:75], a[84:87], a[128:131], v[72:75]
    ds_read_b128 a[12:15], v249 offset:6656
    v_mul_f32 v234, v170, v66
    v_mul_f32 v244, v174, v70
    v_mfma_f32_16x16x32_bf16 v[76:79], a[84:87], a[132:135], v[76:79]
    s_waitcnt lgkmcnt(7)
    ds_read_b128 a[16:19], v249 offset:6864
    v_cvt_pk_bf16_f32 v234, v234, v244
    v_mul_f32 v235, v171, v67
    v_mfma_f32_16x16x32_bf16 v[80:83], a[36:39], a[100:103], v[80:83]
    s_waitcnt lgkmcnt(7)
    ds_read_b128 a[20:23], v249 offset:6720
    v_mul_f32 v245, v175, v71
    v_cvt_pk_bf16_f32 v235, v235, v245
    v_mfma_f32_16x16x32_bf16 v[84:87], a[40:43], a[100:103], v[84:87]
    s_waitcnt lgkmcnt(7)
    ds_read_b128 a[24:27], v249 offset:6928
    buffer_store_dwordx4 v[232:235], v253, s[32:35], 0 offen offset:512 sc1
    v_mfma_f32_16x16x32_bf16 v[80:83], a[44:47], a[104:107], v[80:83]
    s_waitcnt lgkmcnt(7)
    ds_read_b128 a[28:31], v249 offset:6784
    v_mul_f32 v236, v176, v72
    v_mfma_f32_16x16x32_bf16 v[84:87], a[0:3], a[104:107], v[84:87]
    s_waitcnt lgkmcnt(7)
    ds_read_b128 a[32:35], v249 offset:6992
    v_mul_f32 v244, v180, v76
    v_mfma_f32_16x16x32_bf16 v[80:83], a[4:7], a[108:111], v[80:83]
    s_waitcnt lgkmcnt(7)
    ds_read_b64 a[92:93], v250 offset:6656
    v_cvt_pk_bf16_f32 v236, v236, v244
    v_mul_f32 v237, v177, v73
    v_mfma_f32_16x16x32_bf16 v[84:87], a[8:11], a[108:111], v[84:87]
    s_waitcnt lgkmcnt(7)
    v_mul_f32 v245, v181, v77
    v_cvt_pk_bf16_f32 v237, v237, v245
    v_mfma_f32_16x16x32_bf16 v[80:83], a[88:91], a[128:131], v[80:83]
    ds_read_b128 a[36:39], v249 offset:13312
    v_mul_f32 v238, v178, v74
    v_mul_f32 v244, v182, v78
    v_mfma_f32_16x16x32_bf16 v[84:87], a[88:91], a[132:135], v[84:87]
    s_waitcnt lgkmcnt(7)
    ds_read_b128 a[40:43], v249 offset:13520
    v_cvt_pk_bf16_f32 v238, v238, v244
    v_mul_f32 v239, v179, v75
    v_mfma_f32_16x16x32_bf16 v[88:91], a[12:15], a[100:103], v[88:91]
    s_waitcnt lgkmcnt(7)
    ds_read_b128 a[44:47], v249 offset:13376
    v_mul_f32 v245, v183, v79
    v_cvt_pk_bf16_f32 v239, v239, v245
    v_mfma_f32_16x16x32_bf16 v[92:95], a[16:19], a[100:103], v[92:95]
    s_waitcnt lgkmcnt(7)
    ds_read_b128 a[0:3], v249 offset:13584
    buffer_store_dwordx4 v[236:239], v253, s[32:35], 0 offen offset:576 sc1
    v_mfma_f32_16x16x32_bf16 v[88:91], a[20:23], a[104:107], v[88:91]
    s_waitcnt lgkmcnt(7)
    ds_read_b128 a[4:7], v249 offset:13440
    v_mul_f32 v240, v184, v80
    v_mfma_f32_16x16x32_bf16 v[92:95], a[24:27], a[104:107], v[92:95]
    s_waitcnt lgkmcnt(7)
    ds_read_b128 a[8:11], v249 offset:13648
    v_mul_f32 v244, v188, v84
    v_mfma_f32_16x16x32_bf16 v[88:91], a[28:31], a[108:111], v[88:91]
    s_waitcnt lgkmcnt(7)
    ds_read_b64 a[96:97], v250 offset:13312
    v_cvt_pk_bf16_f32 v240, v240, v244
    v_mul_f32 v241, v185, v81
    v_mfma_f32_16x16x32_bf16 v[92:95], a[32:35], a[108:111], v[92:95]
    s_waitcnt lgkmcnt(7)
    v_mul_f32 v245, v189, v85
    v_cvt_pk_bf16_f32 v241, v241, v245
    v_mfma_f32_16x16x32_bf16 v[88:91], a[92:95], a[128:131], v[88:91]
    v_mul_f32 v242, v186, v82
    v_mul_f32 v244, v190, v86
    v_mfma_f32_16x16x32_bf16 v[92:95], a[92:95], a[132:135], v[92:95]
    s_waitcnt lgkmcnt(6)
    v_cvt_pk_bf16_f32 v242, v242, v244
    v_mul_f32 v243, v187, v83
    v_mfma_f32_16x16x32_bf16 v[96:99], a[36:39], a[100:103], v[96:99]
    s_waitcnt lgkmcnt(5)
    v_mul_f32 v245, v191, v87
    v_cvt_pk_bf16_f32 v243, v243, v245
    v_mul_f32 v208, v192, v88
    v_mfma_f32_16x16x32_bf16 v[100:103], a[40:43], a[100:103], v[100:103]
    s_waitcnt lgkmcnt(4)
    buffer_store_dwordx4 v[240:243], v253, s[32:35], 0 offen offset:640 sc1
    v_mul_f32 v244, v196, v92
    v_cvt_pk_bf16_f32 v208, v208, v244
    v_mul_f32 v209, v193, v89
    v_mfma_f32_16x16x32_bf16 v[96:99], a[44:47], a[104:107], v[96:99]
    s_waitcnt lgkmcnt(3)
    v_mul_f32 v245, v197, v93
    v_cvt_pk_bf16_f32 v209, v209, v245
    v_mul_f32 v210, v194, v90
    v_mul_f32 v244, v198, v94
    v_mfma_f32_16x16x32_bf16 v[100:103], a[0:3], a[104:107], v[100:103]
    s_waitcnt lgkmcnt(2)
    v_cvt_pk_bf16_f32 v210, v210, v244
    v_mul_f32 v211, v195, v91
    v_mul_f32 v245, v199, v95
    v_cvt_pk_bf16_f32 v211, v211, v245
    v_mfma_f32_16x16x32_bf16 v[96:99], a[4:7], a[108:111], v[96:99]
    s_waitcnt lgkmcnt(1)
    buffer_store_dwordx4 v[208:211], v253, s[32:35], 0 offen offset:704 sc1
    v_mfma_f32_16x16x32_bf16 v[100:103], a[8:11], a[108:111], v[100:103]
    s_waitcnt lgkmcnt(0)
    v_mfma_f32_16x16x32_bf16 v[96:99], a[96:99], a[128:131], v[96:99]
    v_mfma_f32_16x16x32_bf16 v[100:103], a[96:99], a[132:135], v[100:103]
    s_nop 7
    v_mul_f32 v212, v200, v96
    v_mul_f32 v244, v204, v100
    v_cvt_pk_bf16_f32 v212, v212, v244
    v_mul_f32 v213, v201, v97
    v_mul_f32 v245, v205, v101
    v_cvt_pk_bf16_f32 v213, v213, v245
    v_mul_f32 v214, v202, v98
    v_mul_f32 v244, v206, v102
    v_cvt_pk_bf16_f32 v214, v214, v244
    v_mul_f32 v215, v203, v99
    v_mul_f32 v245, v207, v103
    v_cvt_pk_bf16_f32 v215, v215, v245
    buffer_store_dwordx4 v[212:215], v253, s[32:35], 0 offen offset:768 sc1
L_end:
    s_endpgm
.section .rodata,"a"
.p2align 6
.amdhsa_kernel standalone__cross_network_dcn_v2__recsys_kernel
  .amdhsa_next_free_vgpr 512
  .amdhsa_next_free_sgpr 102
  .amdhsa_accum_offset 256
  .amdhsa_group_segment_fixed_size 0
  .amdhsa_kernarg_size 56
  .amdhsa_user_sgpr_count 2
  .amdhsa_user_sgpr_kernarg_segment_ptr 1
  .amdhsa_system_sgpr_workgroup_id_x 1
.end_amdhsa_kernel
```
